```python
import torch

def _softmax(x, axis=-1):
    return torch.softmax(x, dim=axis)
def _gelu(x):
    return torch.nn.functional.gelu(x, approximate="tanh")
def _silu(x):
    return torch.nn.functional.silu(x)
def _sigmoid(x):
    return torch.sigmoid(x)
def _layernorm(x, axis=-1, eps=1e-5):
    m = x.mean(dim=axis, keepdim=True)
    v = x.var(dim=axis, keepdim=True, unbiased=False)
    return (x - m) / torch.sqrt(v + eps)
def _scatter_add(tgt, idx, src, axis=0):
    return tgt.clone().index_add_(axis, idx, src)
def _segment_sum(src, seg, n):
    out = torch.zeros((n,) + src.shape[1:], dtype=src.dtype)
    return out.index_add_(0, seg, src)
def _pad(x, pw):
    flat = tuple(v for pair in reversed(pw) for v in pair)
    return torch.nn.functional.pad(x, flat)

kernel_name = 'concat_heads__ssm_conv_s5__linear_attn_block__prompt'

def setup_inputs():

    _w = (lambda a: (lambda t: t.to(torch.bfloat16) if t.is_floating_point() else t)(torch.as_tensor(a)))
    def _A_setup():
        B, S, D = 1, 2048, 512
        P = D
        Lambda_re = -0.5 * (lambda _x: torch.exp(torch.as_tensor(_x)))((lambda *s: torch.randn(*s, dtype=torch.bfloat16) * 0.2)(P))
        Lambda_im = (lambda *s: torch.randn(*s, dtype=torch.bfloat16) * 0.8)(P) * 1.0
        B_re = (lambda *s: torch.randn(*s, dtype=torch.bfloat16) * 0.2)(P, D) * (D ** -0.5)
        B_im = (lambda *s: torch.randn(*s, dtype=torch.bfloat16) * 0.2)(P, D) * (D ** -0.5)
        C_re = (lambda *s: torch.randn(*s, dtype=torch.bfloat16) * 0.2)(D, P) * (P ** -0.5)
        C_im = (lambda *s: torch.randn(*s, dtype=torch.bfloat16) * 0.2)(D, P) * (P ** -0.5)
        log_dt = (lambda *s: torch.randn(*s, dtype=torch.bfloat16) * 0.2)(P) * 0.3 - 2.0
        Dskip = (lambda *s: torch.randn(*s, dtype=torch.bfloat16) * 0.05)(D)
        return {
            "x": _w((lambda *s: torch.randn(*s, dtype=torch.bfloat16) * 0.05)(B, S, D)),
            "Lambda_re": _w(Lambda_re),
            "Lambda_im": _w(Lambda_im),
            "B_re": _w(B_re),
            "B_im": _w(B_im),
            "C_re": _w(C_re),
            "C_im": _w(C_im),
            "log_dt": _w(log_dt),
            "Dskip": _w(Dskip),
        }
    _A_in = _A_setup()

    def _B_setup():
        B, S, D = 1, 2048, 512
        return {
            "x": _w((lambda *s: torch.randn(*s, dtype=torch.bfloat16) * 0.05)(B, S, D)),
            "wqkv": _w((lambda *s: torch.randn(*s, dtype=torch.bfloat16) * 0.4)(D, 3 * D)),
            "wo": _w((lambda *s: torch.randn(*s, dtype=torch.bfloat16) * 0.05)(D, D)),
        }
    _B_in = _B_setup()

    return {
        "A_x": _A_in["x"],
        "A_Lambda_re": _A_in["Lambda_re"],
        "A_Lambda_im": _A_in["Lambda_im"],
        "A_B_re": _A_in["B_re"],
        "A_B_im": _A_in["B_im"],
        "A_C_re": _A_in["C_re"],
        "A_C_im": _A_in["C_im"],
        "A_log_dt": _A_in["log_dt"],
        "A_Dskip": _A_in["Dskip"],
        "B_x": _B_in["x"],
        "B_wqkv": _B_in["wqkv"],
        "B_wo": _B_in["wo"],
    }

def reference(A_x, A_Lambda_re, A_Lambda_im, A_B_re, A_B_im, A_C_re, A_C_im, A_log_dt, A_Dskip, B_x, B_wqkv, B_wo):
    def _A_ref(x, Lambda_re, Lambda_im, B_re, B_im, C_re, C_im, log_dt, Dskip):
        Bsz, L, H = x.shape
        Lam = Lambda_re + 1j * Lambda_im
        Bmat = B_re + 1j * B_im
        Cmat = C_re + 1j * C_im
        dt = torch.exp(log_dt)
        Lam_bar = torch.exp(dt * Lam)
        B_bar = ((Lam_bar - 1.0) / Lam)[:, None] * Bmat
        Bu = torch.einsum("bld,pd->blp", x + 0j, B_bar)
        h = torch.zeros_like(Bu[:, 0, :])
        hs = []
        for t in range(L):
            h = Lam_bar[None, :] * h + Bu[:, t, :]
            hs.append(h)
        hseq = torch.stack(hs, 1)
        y = 2.0 * torch.einsum("blp,dp->bld", hseq, Cmat).real + x * Dskip[None, None, :]
        return y

    def _B_ref(x, wqkv, wo):
        B, S, D = x.shape
        H = 32; Dh = D // H
        qkv = (lambda x, *d: x.permute(*d))((x @ wqkv).reshape(B, S, 3, H, Dh), 2, 0, 3, 1, 4)
        q, k, v = qkv[0], qkv[1], qkv[2]
        phi = lambda t: torch.where(t > 0, t + 1, torch.exp(t)) + 1e-6
        pq, pk = phi(q), phi(k)
        kv = torch.einsum("bhsd,bhse->bhde", pk, v)
        z = torch.einsum("bhsd->bhd", pk)
        num = torch.einsum("bhqd,bhde->bhqe", pq, kv)
        den = torch.einsum("bhqd,bhd->bhq", pq, z)[..., None] + 1e-6
        o = num / den
        return (lambda x, *d: x.permute(*d))(o, 0, 2, 1, 3).reshape(B, S, D) @ wo

    a = _A_ref(A_x, A_Lambda_re, A_Lambda_im, A_B_re, A_B_im, A_C_re, A_C_im, A_log_dt, A_Dskip)
    b = _B_ref(B_x, B_wqkv, B_wo)
    return torch.concatenate([a, b], axis=-1)
```

```asm
; @launch grid=(256,1,1) block=(512,1,1) lds=163840
.amdgcn_target "amdgcn-amd-amdhsa--gfx950"
.text
.globl concat_heads__ssm_conv_s5__linear_attn_block__prompt_kernel
.p2align 8
.type concat_heads__ssm_conv_s5__linear_attn_block__prompt_kernel,@function
concat_heads__ssm_conv_s5__linear_attn_block__prompt_kernel:
    s_cmp_ge_u32 s2, 256
    s_cbranch_scc1 K_END
    s_load_dwordx16 s[36:51], s[0:1], 0
    s_load_dwordx8 s[52:59], s[0:1], 64
    s_load_dwordx4 s[60:63], s[0:1], 96
    s_load_dwordx2 s[64:65], s[0:1], 112
    s_getpc_b64 s[96:97]
K_PC:
    v_and_b32 v1, 63, v0
    v_lshrrev_b32 v214, 6, v0
    s_nop 0
    v_readfirstlane_b32 s66, v214
    s_and_b32 s72, s2, 7
    s_lshr_b32 s73, s2, 3
    s_lshr_b32 s69, s72, 2
    s_and_b32 s72, s72, 3
    s_lshl_b32 s67, s72, 2
    s_lshr_b32 s74, s73, 3
    s_add_u32 s67, s67, s74
    s_and_b32 s68, s73, 7
    s_mul_i32 s72, s69, K_B-K_PC-0x400
    s_and_b32 s74, s73, 1
    s_lshl_b32 s74, s74, 13
    s_add_u32 s72, s72, s74
    s_add_u32 s72, s72, 0x400
    v_lshl_add_u32 v148, v0, 4, s72
    v_min_u32 v149, K_END-K_PC-16, v148
    global_load_dwordx4 v[132:135], v149, s[96:97]
    s_and_b32 s70, s66, 3
    s_lshr_b32 s71, s66, 2
    s_lshl_b32 s76, s66, 10
    s_lshl_b32 s77, s66, 11
    s_mov_b32 s82, 0
    s_mov_b32 s83, -1
    s_mov_b32 s100, 0x0000ffff
    s_mov_b32 s101, 0x0000ffff
    v_and_b32 v2, 31, v0
    v_lshrrev_b32 v3, 5, v1
    v_and_b32 v222, 15, v0
    v_lshrrev_b32 v223, 4, v1
    v_mov_b32 v254, 0
    s_lshl_b32 s72, s70, 2
    v_add_u32 v214, s72, v223
    v_xor_b32 v215, v222, v214
    v_lshrrev_b32 v216, 3, v215
    v_and_b32 v215, 7, v215
    v_lshl_add_u32 v214, v223, 1, v216
    s_lshl_b32 s72, s66, 3
    v_add_u32 v214, s72, v214
    v_lshlrev_b32 v214, 10, v214
    v_lshl_add_u32 v84, v215, 4, v214
    s_lshl_b32 s72, s67, 17
    v_add_u32 v224, s72, v84
    s_lshl_b32 s72, s68, 16
    v_add_u32 v225, s72, v84
    v_lshrrev_b32 v214, 1, v2
    v_and_b32 v215, 1, v2
    v_lshl_add_u32 v215, v215, 3, v3
    v_xor_b32 v215, v215, v214
    v_lshlrev_b32 v215, 4, v215
    v_lshl_add_u32 v253, v214, 8, v215
    s_cmp_lg_u32 s69, 0
    s_cbranch_scc1 K_B
    s_lshl_b32 s72, s68, 7
    s_lshl_b32 s73, s71, 6
    s_add_u32 s72, s72, s73
    v_lshl_add_u32 v214, v2, 1, s72
    v_mov_b32 v87, v214
    s_lshl_b32 s73, s71, 2
    v_lshrrev_b32 v215, 3, v2
    v_add_u32 v215, s73, v215
    v_lshlrev_b32 v216, 1, v3
    v_xor_b32 v215, v215, v216
    v_lshlrev_b32 v215, 4, v215
    v_lshl_add_u32 v215, v3, 9, v215
    v_and_b32 v216, 7, v2
    v_lshl_add_u32 v215, v216, 1, v215
    s_lshl_b32 s73, s70, 12
    v_add_u32 v178, s73, v215
    s_mov_b32 s6, 0x200000
    s_mov_b32 s7, 0x00020000
    s_mov_b32 s10, 0x80000
    s_mov_b32 s11, 0x00020000
    s_mov_b32 s14, 0x80000
    s_mov_b32 s15, 0x00020000
    s_and_b32 s73, s68, 6
    s_add_u32 s72, s67, s73
    s_and_b32 s72, s72, 7
    s_lshl_b32 s3, s72, 7
    s_add_u32 s78, s3, 0x10000
    s_lshl_b32 s72, s70, 12
    v_xor_b32 v216, 0, v253
    v_add_u32 v229, s72, v216
    v_add_u32 v233, 0x10000, v229
    v_add_u32 v237, 0x20000, v229
    v_xor_b32 v216, 32, v253
    v_add_u32 v230, s72, v216
    v_add_u32 v234, 0x10000, v230
    v_add_u32 v238, 0x20000, v230
    v_xor_b32 v216, 64, v253
    v_add_u32 v231, s72, v216
    v_add_u32 v235, 0x10000, v231
    v_add_u32 v239, 0x20000, v231
    v_xor_b32 v216, 96, v253
    v_add_u32 v232, s72, v216
    v_add_u32 v236, 0x10000, v232
    v_add_u32 v240, 0x20000, v232
    s_mov_b32 m0, s76
    s_waitcnt lgkmcnt(0)
    s_mov_b64 s[4:5], s[36:37]
    global_load_ushort v84, v87, s[38:39]
    global_load_ushort v85, v87, s[40:41]
    global_load_ushort v86, v87, s[50:51]
    global_load_ushort v164, v87, s[52:53]
    buffer_load_dwordx4 v224, s[4:7], s3 offen lds
    s_add_u32 m0, s76, 0x2000
    s_mov_b64 s[8:9], s[42:43]
    buffer_load_dwordx4 v224, s[4:7], s78 offen lds
    s_add_u32 m0, s76, 0x4000
    s_mov_b64 s[12:13], s[44:45]
    buffer_load_dwordx4 v225, s[8:11], s3 offen lds
    s_add_u32 m0, s76, 0x6000
    s_nop 0
    buffer_load_dwordx4 v225, s[12:15], s3 offen lds
    s_mov_b32 s16, s64
    s_and_b32 s17, s65, 0xffff
    s_mov_b32 s18, 0x10000000
    s_mov_b32 s19, 0x00020000
    s_mov_b32 s20, s62
    s_and_b32 s21, s63, 0xffff
    s_mov_b32 s22, 0x100
    s_mov_b32 s23, 0x00020000
    s_mov_b32 s24, s60
    s_and_b32 s25, s61, 0xffff
    s_mov_b32 s26, 0x800000
    s_mov_b32 s27, 0x00020000
    s_or_b32 s72, s2, s66
    s_cmp_lg_u32 s72, 0
    s_cbranch_scc1 K_NONW
    s_memrealtime s[80:81]
    s_waitcnt lgkmcnt(0)
    s_or_b32 s80, s80, 1
    v_mov_b32 v220, s80
    v_mov_b32 v221, s81
    buffer_store_dwordx2 v[220:221], v254, s[20:23], 0 offen sc1
K_NONW:
    s_nop 1
    s_mov_b32 s28, s46
    s_and_b32 s29, s47, 0xffff
    s_mov_b32 s30, 0x80000
    s_mov_b32 s31, 0x00020000
    s_mov_b32 s32, s48
    s_and_b32 s33, s49, 0xffff
    s_mov_b32 s34, 0x80000
    s_mov_b32 s35, 0x00020000
    s_lshl_b32 s72, s67, 1
    s_and_b32 s73, s68, 6
    s_add_u32 s72, s67, s73
    s_add_u32 s58, s72, 0
    s_and_b32 s58, s58, 7
    s_add_u32 s59, s72, 1
    s_and_b32 s59, s59, 7
    s_add_u32 s60, s72, 2
    s_and_b32 s60, s60, 7
    s_add_u32 s61, s72, 3
    s_and_b32 s61, s61, 7
    s_add_u32 s62, s72, 4
    s_and_b32 s62, s62, 7
    s_add_u32 s63, s72, 5
    s_and_b32 s63, s63, 7
    s_add_u32 s64, s72, 6
    s_and_b32 s64, s64, 7
    s_add_u32 s65, s72, 7
    s_and_b32 s65, s65, 7
    s_add_u32 s42, s68, 0
    s_and_b32 s42, s42, 7
    s_add_u32 s43, s68, 1
    s_and_b32 s43, s43, 7
    s_add_u32 s44, s68, 2
    s_and_b32 s44, s44, 7
    s_add_u32 s45, s68, 3
    s_and_b32 s45, s45, 7
    s_add_u32 s46, s68, 4
    s_and_b32 s46, s46, 7
    s_add_u32 s47, s68, 5
    s_and_b32 s47, s47, 7
    s_add_u32 s48, s68, 6
    s_and_b32 s48, s48, 7
    s_add_u32 s49, s68, 7
    s_and_b32 s49, s49, 7
    s_barrier
    s_add_u32 m0, s76, 0x8000
    s_mul_i32 s78, s59, 0x80
    buffer_load_dwordx4 v224, s[4:7], s78 offen lds
    s_add_u32 m0, s76, 0xa000
    s_mul_i32 s78, s59, 0x80
    s_add_u32 s78, s78, 0x10000
    buffer_load_dwordx4 v224, s[4:7], s78 offen lds
    s_add_u32 m0, s76, 0xc000
    s_mul_i32 s78, s59, 0x80
    buffer_load_dwordx4 v225, s[8:11], s78 offen lds
    s_add_u32 m0, s76, 0xe000
    s_mul_i32 s78, s59, 0x80
    buffer_load_dwordx4 v225, s[12:15], s78 offen lds
    s_lshl_b32 s73, s71, 12
    s_add_u32 s73, s73, 0x4000
    v_xor_b32 v216, 0, v253
    v_add_u32 v241, s73, v216
    v_add_u32 v245, 0x10000, v241
    v_add_u32 v249, 0x20000, v241
    v_xor_b32 v216, 32, v253
    v_add_u32 v242, s73, v216
    v_add_u32 v246, 0x10000, v242
    v_add_u32 v250, 0x20000, v242
    v_xor_b32 v216, 64, v253
    v_add_u32 v243, s73, v216
    v_add_u32 v247, 0x10000, v243
    v_add_u32 v251, 0x20000, v243
    v_xor_b32 v216, 96, v253
    v_add_u32 v244, s73, v216
    v_add_u32 v248, 0x10000, v244
    v_add_u32 v252, 0x20000, v244
    s_waitcnt vmcnt(8)
    s_lshl_b32 s74, s67, 18
    s_lshl_b32 s73, s68, 14
    s_add_u32 s74, s74, s73
    s_lshl_b32 s73, s70, 12
    s_add_u32 s74, s74, s73
    s_lshl_b32 s73, s71, 11
    s_add_u32 s74, s74, s73
    v_and_b32 v177, 1, v223
    v_lshlrev_b32 v177, 5, v177
    v_lshl_add_u32 v177, v3, 4, v177
    v_lshl_add_u32 v177, v222, 6, v177
    v_add_u32 v176, s74, v177
    v_and_b32 v177, 0x3fff, v176
    v_lshlrev_b32 v84, 16, v84
    v_lshlrev_b32 v85, 16, v85
    v_lshlrev_b32 v86, 16, v86
    v_mul_f32 v87, 0x3fb8aa3b, v86
    v_exp_f32 v87, v87
    s_nop 0
    v_cvt_pk_bf16_f32 v87, v87, v87
    v_lshlrev_b32 v87, 16, v87
    v_pk_mul_f32 v[88:89], v[86:87], v[84:85] op_sel:[1,0] op_sel_hi:[1,1]
    v_mul_f32 v88, 0x3fb8aa3b, v88
    v_exp_f32 v90, v88
    v_mul_f32 v89, 0x3e22f983, v89
    v_fract_f32 v89, v89
    v_sin_f32 v91, v89
    v_cos_f32 v92, v89
    s_nop 0
    v_mul_f32 v180, v90, v92
    v_mul_f32 v181, v90, v91
    v_add_f32 v93, -1.0, v180
    v_mul_f32 v94, v84, v84
    v_fma_f32 v94, v85, v85, v94
    v_rcp_f32 v95, v94
    s_nop 0
    v_fma_f32 v94, -v94, v95, 1.0
    v_fma_f32 v94, v94, v95, v95
    v_mul_f32 v192, v93, v84
    v_fma_f32 v192, v181, v85, v192
    v_mul_f32 v193, v181, v84
    v_fma_f32 v193, -v93, v85, v193
    v_pk_mul_f32 v[192:193], v[192:193], v[94:95] op_sel:[0,0] op_sel_hi:[1,0]
    v_pk_mul_f32 v[182:183], v[180:181], v[180:181] op_sel:[0,0] op_sel_hi:[0,1]
    v_pk_fma_f32 v[182:183], v[180:181], v[180:181], v[182:183] op_sel:[1,1,0] op_sel_hi:[1,0,1] neg_lo:[1,0,0]
    v_pk_mul_f32 v[184:185], v[182:183], v[180:181] op_sel:[0,0] op_sel_hi:[0,1]
    v_pk_fma_f32 v[184:185], v[182:183], v[180:181], v[184:185] op_sel:[1,1,0] op_sel_hi:[1,0,1] neg_lo:[1,0,0]
    v_pk_mul_f32 v[186:187], v[182:183], v[182:183] op_sel:[0,0] op_sel_hi:[0,1]
    v_pk_fma_f32 v[186:187], v[182:183], v[182:183], v[186:187] op_sel:[1,1,0] op_sel_hi:[1,0,1] neg_lo:[1,0,0]
    v_pk_mul_f32 v[100:101], v[186:187], v[186:187] op_sel:[0,0] op_sel_hi:[0,1]
    v_pk_fma_f32 v[100:101], v[186:187], v[186:187], v[100:101] op_sel:[1,1,0] op_sel_hi:[1,0,1] neg_lo:[1,0,0]
    v_pk_mul_f32 v[102:103], v[100:101], v[100:101] op_sel:[0,0] op_sel_hi:[0,1]
    v_pk_fma_f32 v[102:103], v[100:101], v[100:101], v[102:103] op_sel:[1,1,0] op_sel_hi:[1,0,1] neg_lo:[1,0,0]
    v_pk_mul_f32 v[104:105], v[102:103], v[100:101] op_sel:[0,0] op_sel_hi:[0,1]
    v_pk_fma_f32 v[104:105], v[102:103], v[100:101], v[104:105] op_sel:[1,1,0] op_sel_hi:[1,0,1] neg_lo:[1,0,0]
    v_pk_mul_f32 v[188:189], v[102:103], v[102:103] op_sel:[0,0] op_sel_hi:[0,1]
    v_pk_fma_f32 v[188:189], v[102:103], v[102:103], v[188:189] op_sel:[1,1,0] op_sel_hi:[1,0,1] neg_lo:[1,0,0]
    v_pk_mul_f32 v[106:107], v[188:189], v[188:189] op_sel:[0,0] op_sel_hi:[0,1]
    v_pk_fma_f32 v[106:107], v[188:189], v[188:189], v[106:107] op_sel:[1,1,0] op_sel_hi:[1,0,1] neg_lo:[1,0,0]
    v_pk_mul_f32 v[108:109], v[106:107], v[188:189] op_sel:[0,0] op_sel_hi:[0,1]
    v_pk_fma_f32 v[108:109], v[106:107], v[188:189], v[108:109] op_sel:[1,1,0] op_sel_hi:[1,0,1] neg_lo:[1,0,0]
    v_pk_mul_f32 v[190:191], v[106:107], v[106:107] op_sel:[0,0] op_sel_hi:[0,1]
    v_pk_fma_f32 v[190:191], v[106:107], v[106:107], v[190:191] op_sel:[1,1,0] op_sel_hi:[1,0,1] neg_lo:[1,0,0]
    v_mov_b32 v194, 1.0
    v_mov_b32 v195, 0
    s_cmp_eq_u32 s70, 1
    s_cselect_b64 s[80:81], -1, 0
    v_cndmask_b32 v194, v194, v188, s[80:81]
    v_cndmask_b32 v195, v195, v189, s[80:81]
    s_cmp_eq_u32 s70, 2
    s_cselect_b64 s[80:81], -1, 0
    v_cndmask_b32 v194, v194, v106, s[80:81]
    v_cndmask_b32 v195, v195, v107, s[80:81]
    s_cmp_eq_u32 s70, 3
    s_cselect_b64 s[80:81], -1, 0
    v_cndmask_b32 v194, v194, v108, s[80:81]
    v_cndmask_b32 v195, v195, v109, s[80:81]
    v_mov_b32 v196, 1.0
    s_add_u32 m0, s76, 0x10000
    s_mul_i32 s78, s60, 0x80
    buffer_load_dwordx4 v224, s[4:7], s78 offen lds
    s_add_u32 m0, s76, 0x12000
    s_mul_i32 s78, s60, 0x80
    s_add_u32 s78, s78, 0x10000
    buffer_load_dwordx4 v224, s[4:7], s78 offen lds
    s_add_u32 m0, s76, 0x14000
    s_mul_i32 s78, s60, 0x80
    buffer_load_dwordx4 v225, s[8:11], s78 offen lds
    s_add_u32 m0, s76, 0x16000
    s_mul_i32 s78, s60, 0x80
    buffer_load_dwordx4 v225, s[12:15], s78 offen lds
    v_mov_b32 v197, 0
    v_cndmask_b32 v196, v196, v186, s[82:83]
    v_cndmask_b32 v197, v197, v187, s[82:83]
    v_pk_mul_f32 v[198:199], v[196:197], v[100:101] op_sel:[0,0] op_sel_hi:[0,1]
    v_pk_fma_f32 v[198:199], v[196:197], v[100:101], v[198:199] op_sel:[1,1,0] op_sel_hi:[1,0,1] neg_lo:[1,0,0]
    v_pk_mul_f32 v[200:201], v[196:197], v[102:103] op_sel:[0,0] op_sel_hi:[0,1]
    v_pk_fma_f32 v[200:201], v[196:197], v[102:103], v[200:201] op_sel:[1,1,0] op_sel_hi:[1,0,1] neg_lo:[1,0,0]
    v_pk_mul_f32 v[202:203], v[196:197], v[104:105] op_sel:[0,0] op_sel_hi:[0,1]
    v_pk_fma_f32 v[202:203], v[196:197], v[104:105], v[202:203] op_sel:[1,1,0] op_sel_hi:[1,0,1] neg_lo:[1,0,0]
    v_pk_mul_f32 v[174:175], v[186:187], v[182:183] op_sel:[0,0] op_sel_hi:[0,1]
    v_pk_fma_f32 v[174:175], v[186:187], v[182:183], v[174:175] op_sel:[1,1,0] op_sel_hi:[1,0,1] neg_lo:[1,0,0]
    v_pk_mul_f32 v[110:111], v[192:193], v[194:195] op_sel:[0,0] op_sel_hi:[0,1]
    v_pk_fma_f32 v[110:111], v[192:193], v[194:195], v[110:111] op_sel:[1,1,0] op_sel_hi:[1,0,1] neg_lo:[1,0,0]
    v_pk_mul_f32 v[116:117], v[110:111], v[196:197] op_sel:[0,0] op_sel_hi:[0,1]
    v_pk_fma_f32 v[116:117], v[110:111], v[196:197], v[116:117] op_sel:[1,1,0] op_sel_hi:[1,0,1] neg_lo:[1,0,0]
    v_pk_mul_f32 v[118:119], v[110:111], v[198:199] op_sel:[0,0] op_sel_hi:[0,1]
    v_pk_fma_f32 v[118:119], v[110:111], v[198:199], v[118:119] op_sel:[1,1,0] op_sel_hi:[1,0,1] neg_lo:[1,0,0]
    v_pk_mul_f32 v[120:121], v[110:111], v[200:201] op_sel:[0,0] op_sel_hi:[0,1]
    v_pk_fma_f32 v[120:121], v[110:111], v[200:201], v[120:121] op_sel:[1,1,0] op_sel_hi:[1,0,1] neg_lo:[1,0,0]
    v_pk_mul_f32 v[122:123], v[110:111], v[202:203] op_sel:[0,0] op_sel_hi:[0,1]
    v_pk_fma_f32 v[122:123], v[110:111], v[202:203], v[122:123] op_sel:[1,1,0] op_sel_hi:[1,0,1] neg_lo:[1,0,0]
    v_pk_mul_f32 v[68:69], v[190:191], v[190:191] op_sel:[0,0] op_sel_hi:[0,1]
    v_pk_fma_f32 v[68:69], v[190:191], v[190:191], v[68:69] op_sel:[1,1,0] op_sel_hi:[1,0,1] neg_lo:[1,0,0]
    v_pk_mul_f32 v[70:71], v[68:69], v[68:69] op_sel:[0,0] op_sel_hi:[0,1]
    v_pk_fma_f32 v[70:71], v[68:69], v[68:69], v[70:71] op_sel:[1,1,0] op_sel_hi:[1,0,1] neg_lo:[1,0,0]
    v_pk_mul_f32 v[72:73], v[70:71], v[68:69] op_sel:[0,0] op_sel_hi:[0,1]
    v_pk_fma_f32 v[72:73], v[70:71], v[68:69], v[72:73] op_sel:[1,1,0] op_sel_hi:[1,0,1] neg_lo:[1,0,0]
    v_pk_mul_f32 v[74:75], v[70:71], v[70:71] op_sel:[0,0] op_sel_hi:[0,1]
    v_pk_fma_f32 v[74:75], v[70:71], v[70:71], v[74:75] op_sel:[1,1,0] op_sel_hi:[1,0,1] neg_lo:[1,0,0]
    v_mov_b32 v76, 1.0
    v_mov_b32 v77, 0
    s_cmp_eq_u32 s70, 1
    s_cselect_b64 s[80:81], -1, 0
    v_cndmask_b32 v76, v76, v68, s[80:81]
    v_cndmask_b32 v77, v77, v69, s[80:81]
    s_cmp_eq_u32 s70, 2
    s_cselect_b64 s[80:81], -1, 0
    v_cndmask_b32 v76, v76, v70, s[80:81]
    v_cndmask_b32 v77, v77, v71, s[80:81]
    s_cmp_eq_u32 s70, 3
    s_cselect_b64 s[80:81], -1, 0
    v_cndmask_b32 v76, v76, v72, s[80:81]
    v_cndmask_b32 v77, v77, v73, s[80:81]
    v_mov_b32 v78, 1.0
    v_mov_b32 v79, 0
    v_cndmask_b32 v78, v78, v190, s[82:83]
    v_cndmask_b32 v79, v79, v191, s[82:83]
    v_pk_mul_f32 v[166:167], v[76:77], v[78:79] op_sel:[0,0] op_sel_hi:[0,1]
    v_pk_fma_f32 v[166:167], v[76:77], v[78:79], v[166:167] op_sel:[1,1,0] op_sel_hi:[1,0,1] neg_lo:[1,0,0]
    v_pk_mul_f32 v[168:169], v[166:167], v[74:75] op_sel:[0,0] op_sel_hi:[0,1]
    v_pk_fma_f32 v[168:169], v[166:167], v[74:75], v[168:169] op_sel:[1,1,0] op_sel_hi:[1,0,1] neg_lo:[1,0,0]
    v_lshlrev_b32 v80, 1, s70
    v_add_u32 v80, v80, v3
    v_sub_u32 v80, s67, v80
    v_subrev_u32 v80, 1, v80
    v_subrev_u32 v81, 8, v80
    v_lshlrev_b32 v78, 14, s68
    v_lshlrev_b32 v79, 9, s71
    v_add_u32 v78, v78, v79
    v_lshl_add_u32 v78, v2, 4, v78
    v_add_u32 v78, 0x600000, v78
    v_cmp_gt_i32 s[80:81], 0, v80
    s_nop 1
    v_cndmask_b32 v166, v166, v254, s[80:81]
    v_cndmask_b32 v167, v167, v254, s[80:81]
    v_max_i32 v80, 0, v80
    v_lshl_add_u32 v170, v80, 10, v78
    v_cmp_gt_i32 s[80:81], 0, v81
    s_nop 1
    v_cndmask_b32 v168, v168, v254, s[80:81]
    v_cndmask_b32 v169, v169, v254, s[80:81]
    v_max_i32 v81, 0, v81
    v_lshl_add_u32 v171, v81, 10, v78
    s_waitcnt vmcnt(8)
    s_barrier
    ds_read_b128 v[4:7], v229 offset:0
    ds_read_b128 v[8:11], v241 offset:0
    ds_read_b128 v[12:15], v241 offset:8192
    ds_read_b128 v[20:23], v230 offset:0
    ds_read_b128 v[24:27], v242 offset:0
    ds_read_b128 v[28:31], v242 offset:8192
    s_waitcnt lgkmcnt(3)
    v_mfma_f32_32x32x16_bf16 v[36:51], v[4:7], v[8:11], 0
    v_mfma_f32_32x32x16_bf16 v[52:67], v[4:7], v[12:15], 0
    ds_read_b128 v[4:7], v231 offset:0
    ds_read_b128 v[8:11], v243 offset:0
    ds_read_b128 v[12:15], v243 offset:8192
    s_waitcnt lgkmcnt(3)
    v_mfma_f32_32x32x16_bf16 v[36:51], v[20:23], v[24:27], v[36:51]
    v_mfma_f32_32x32x16_bf16 v[52:67], v[20:23], v[28:31], v[52:67]
    ds_read_b128 v[20:23], v232 offset:0
    ds_read_b128 v[24:27], v244 offset:0
    ds_read_b128 v[28:31], v244 offset:8192
    s_waitcnt lgkmcnt(3)
    v_mfma_f32_32x32x16_bf16 v[36:51], v[4:7], v[8:11], v[36:51]
    v_mfma_f32_32x32x16_bf16 v[52:67], v[4:7], v[12:15], v[52:67]
    s_waitcnt vmcnt(4)
    s_barrier
    ds_read_b128 v[4:7], v229 offset:32768
    ds_read_b128 v[8:11], v241 offset:32768
    ds_read_b128 v[12:15], v241 offset:40960
    s_add_u32 m0, s76, 0x18000
    s_mul_i32 s78, s61, 0x80
    buffer_load_dwordx4 v224, s[4:7], s78 offen lds
    s_add_u32 m0, s76, 0x1a000
    s_mul_i32 s78, s61, 0x80
    s_add_u32 s78, s78, 0x10000
    buffer_load_dwordx4 v224, s[4:7], s78 offen lds
    s_cmp_lg_u32 s58, s68
    s_cbranch_scc1 KA_XG0
    v_xor_b32 v214, 0x0, v178
    ds_read_u16 v148, v214 offset:0
    v_xor_b32 v215, 0x80, v178
    ds_read_u16 v149, v215 offset:0
    v_xor_b32 v216, 0x10, v178
    ds_read_u16 v150, v216 offset:256
    v_xor_b32 v217, 0x90, v178
    ds_read_u16 v151, v217 offset:256
    v_xor_b32 v214, 0x40, v178
    ds_read_u16 v152, v214 offset:1024
    v_xor_b32 v215, 0xc0, v178
    ds_read_u16 v153, v215 offset:1024
    v_xor_b32 v216, 0x50, v178
    ds_read_u16 v154, v216 offset:1280
    v_xor_b32 v217, 0xd0, v178
    ds_read_u16 v155, v217 offset:1280
    v_xor_b32 v214, 0x80, v178
    ds_read_u16 v156, v214 offset:2048
    v_xor_b32 v215, 0x0, v178
    ds_read_u16 v157, v215 offset:2048
    v_xor_b32 v216, 0x90, v178
    ds_read_u16 v158, v216 offset:2304
    v_xor_b32 v217, 0x10, v178
    ds_read_u16 v159, v217 offset:2304
    v_xor_b32 v214, 0xc0, v178
    ds_read_u16 v160, v214 offset:3072
    v_xor_b32 v215, 0x40, v178
    ds_read_u16 v161, v215 offset:3072
    v_xor_b32 v216, 0xd0, v178
    ds_read_u16 v162, v216 offset:3328
    v_xor_b32 v217, 0x50, v178
    ds_read_u16 v163, v217 offset:3328
    s_waitcnt lgkmcnt(0)
KA_XG0:
    s_nop 1
    s_waitcnt lgkmcnt(3)
    v_mfma_f32_32x32x16_bf16 v[36:51], v[20:23], v[24:27], v[36:51]
    s_add_u32 m0, s76, 0x1c000
    s_mul_i32 s78, s61, 0x80
    buffer_load_dwordx4 v225, s[8:11], s78 offen lds
    s_add_u32 m0, s76, 0x1e000
    s_mul_i32 s78, s61, 0x80
    buffer_load_dwordx4 v225, s[12:15], s78 offen lds
    v_mfma_f32_32x32x16_bf16 v[52:67], v[20:23], v[28:31], v[52:67]
    ds_read_b128 v[20:23], v230 offset:32768
    ds_read_b128 v[24:27], v242 offset:32768
    ds_read_b128 v[28:31], v242 offset:40960
    s_waitcnt lgkmcnt(3)
    v_mfma_f32_32x32x16_bf16 v[36:51], v[4:7], v[8:11], v[36:51]
    s_add_u32 m0, s76, 0x20000
    s_mul_i32 s78, s62, 0x80
    buffer_load_dwordx4 v224, s[4:7], s78 offen lds
    s_add_u32 m0, s76, 0x22000
    s_mul_i32 s78, s62, 0x80
    s_add_u32 s78, s78, 0x10000
    buffer_load_dwordx4 v224, s[4:7], s78 offen lds
    v_mfma_f32_32x32x16_bf16 v[52:67], v[4:7], v[12:15], v[52:67]
    ds_read_b128 v[4:7], v231 offset:32768
    ds_read_b128 v[8:11], v243 offset:32768
    ds_read_b128 v[12:15], v243 offset:40960
    s_waitcnt lgkmcnt(3)
    v_mfma_f32_32x32x16_bf16 v[36:51], v[20:23], v[24:27], v[36:51]
    s_add_u32 m0, s76, 0x24000
    s_mul_i32 s78, s62, 0x80
    buffer_load_dwordx4 v225, s[8:11], s78 offen lds
    s_add_u32 m0, s76, 0x26000
    s_mul_i32 s78, s62, 0x80
    buffer_load_dwordx4 v225, s[12:15], s78 offen lds
    v_mfma_f32_32x32x16_bf16 v[52:67], v[20:23], v[28:31], v[52:67]
    ds_read_b128 v[20:23], v232 offset:32768
    ds_read_b128 v[24:27], v244 offset:32768
    ds_read_b128 v[28:31], v244 offset:40960
    s_waitcnt lgkmcnt(3)
    v_mfma_f32_32x32x16_bf16 v[36:51], v[4:7], v[8:11], v[36:51]
    v_mfma_f32_32x32x16_bf16 v[52:67], v[4:7], v[12:15], v[52:67]
    s_waitcnt vmcnt(8)
    s_barrier
    ds_read_b128 v[4:7], v233 offset:0
    ds_read_b128 v[8:11], v245 offset:0
    ds_read_b128 v[12:15], v245 offset:8192
    s_add_u32 m0, s76, 0x0
    s_mul_i32 s78, s63, 0x80
    buffer_load_dwordx4 v224, s[4:7], s78 offen lds
    s_cmp_lg_u32 s59, s68
    s_cbranch_scc1 KA_XG1
    v_xor_b32 v214, 0x0, v178
    ds_read_u16 v148, v214 offset:32768
    v_xor_b32 v215, 0x80, v178
    ds_read_u16 v149, v215 offset:32768
    v_xor_b32 v216, 0x10, v178
    ds_read_u16 v150, v216 offset:33024
    v_xor_b32 v217, 0x90, v178
    ds_read_u16 v151, v217 offset:33024
    v_xor_b32 v214, 0x40, v178
    ds_read_u16 v152, v214 offset:33792
    v_xor_b32 v215, 0xc0, v178
    ds_read_u16 v153, v215 offset:33792
    v_xor_b32 v216, 0x50, v178
    ds_read_u16 v154, v216 offset:34048
    v_xor_b32 v217, 0xd0, v178
    ds_read_u16 v155, v217 offset:34048
    v_xor_b32 v214, 0x80, v178
    ds_read_u16 v156, v214 offset:34816
    v_xor_b32 v215, 0x0, v178
    ds_read_u16 v157, v215 offset:34816
    v_xor_b32 v216, 0x90, v178
    ds_read_u16 v158, v216 offset:35072
    v_xor_b32 v217, 0x10, v178
    ds_read_u16 v159, v217 offset:35072
    v_xor_b32 v214, 0xc0, v178
    ds_read_u16 v160, v214 offset:35840
    v_xor_b32 v215, 0x40, v178
    ds_read_u16 v161, v215 offset:35840
    v_xor_b32 v216, 0xd0, v178
    ds_read_u16 v162, v216 offset:36096
    v_xor_b32 v217, 0x50, v178
    ds_read_u16 v163, v217 offset:36096
    s_waitcnt lgkmcnt(0)
KA_XG1:
    s_nop 1
    s_waitcnt lgkmcnt(3)
    v_mfma_f32_32x32x16_bf16 v[36:51], v[20:23], v[24:27], v[36:51]
    s_add_u32 m0, s76, 0x2000
    s_mul_i32 s78, s63, 0x80
    s_add_u32 s78, s78, 0x10000
    buffer_load_dwordx4 v224, s[4:7], s78 offen lds
    v_mfma_f32_32x32x16_bf16 v[52:67], v[20:23], v[28:31], v[52:67]
    ds_read_b128 v[20:23], v234 offset:0
    ds_read_b128 v[24:27], v246 offset:0
    ds_read_b128 v[28:31], v246 offset:8192
    s_waitcnt lgkmcnt(3)
    v_mfma_f32_32x32x16_bf16 v[36:51], v[4:7], v[8:11], v[36:51]
    s_add_u32 m0, s76, 0x4000
    s_mul_i32 s78, s63, 0x80
    buffer_load_dwordx4 v225, s[8:11], s78 offen lds
    v_mfma_f32_32x32x16_bf16 v[52:67], v[4:7], v[12:15], v[52:67]
    ds_read_b128 v[4:7], v235 offset:0
    ds_read_b128 v[8:11], v247 offset:0
    ds_read_b128 v[12:15], v247 offset:8192
    s_waitcnt lgkmcnt(3)
    v_mfma_f32_32x32x16_bf16 v[36:51], v[20:23], v[24:27], v[36:51]
    s_add_u32 m0, s76, 0x6000
    s_mul_i32 s78, s63, 0x80
    buffer_load_dwordx4 v225, s[12:15], s78 offen lds
    v_mfma_f32_32x32x16_bf16 v[52:67], v[20:23], v[28:31], v[52:67]
    ds_read_b128 v[20:23], v236 offset:0
    ds_read_b128 v[24:27], v248 offset:0
    ds_read_b128 v[28:31], v248 offset:8192
    s_waitcnt lgkmcnt(3)
    v_mfma_f32_32x32x16_bf16 v[36:51], v[4:7], v[8:11], v[36:51]
    v_mfma_f32_32x32x16_bf16 v[52:67], v[4:7], v[12:15], v[52:67]
    s_waitcnt vmcnt(8)
    s_barrier
    ds_read_b128 v[4:7], v233 offset:32768
    ds_read_b128 v[8:11], v245 offset:32768
    ds_read_b128 v[12:15], v245 offset:40960
    s_add_u32 m0, s76, 0x8000
    s_mul_i32 s78, s64, 0x80
    buffer_load_dwordx4 v224, s[4:7], s78 offen lds
    s_cmp_lg_u32 s60, s68
    s_cbranch_scc1 KA_XG2
    v_xor_b32 v214, 0x10000, v178
    ds_read_u16 v148, v214 offset:0
    v_xor_b32 v215, 0x10080, v178
    ds_read_u16 v149, v215 offset:0
    v_xor_b32 v216, 0x10010, v178
    ds_read_u16 v150, v216 offset:256
    v_xor_b32 v217, 0x10090, v178
    ds_read_u16 v151, v217 offset:256
    v_xor_b32 v214, 0x10040, v178
    ds_read_u16 v152, v214 offset:1024
    v_xor_b32 v215, 0x100c0, v178
    ds_read_u16 v153, v215 offset:1024
    v_xor_b32 v216, 0x10050, v178
    ds_read_u16 v154, v216 offset:1280
    v_xor_b32 v217, 0x100d0, v178
    ds_read_u16 v155, v217 offset:1280
    v_xor_b32 v214, 0x10080, v178
    ds_read_u16 v156, v214 offset:2048
    v_xor_b32 v215, 0x10000, v178
    ds_read_u16 v157, v215 offset:2048
    v_xor_b32 v216, 0x10090, v178
    ds_read_u16 v158, v216 offset:2304
    v_xor_b32 v217, 0x10010, v178
    ds_read_u16 v159, v217 offset:2304
    v_xor_b32 v214, 0x100c0, v178
    ds_read_u16 v160, v214 offset:3072
    v_xor_b32 v215, 0x10040, v178
    ds_read_u16 v161, v215 offset:3072
    v_xor_b32 v216, 0x100d0, v178
    ds_read_u16 v162, v216 offset:3328
    v_xor_b32 v217, 0x10050, v178
    ds_read_u16 v163, v217 offset:3328
    s_waitcnt lgkmcnt(0)
KA_XG2:
    s_nop 1
    s_waitcnt lgkmcnt(3)
    v_mfma_f32_32x32x16_bf16 v[36:51], v[20:23], v[24:27], v[36:51]
    s_add_u32 m0, s76, 0xa000
    s_mul_i32 s78, s64, 0x80
    s_add_u32 s78, s78, 0x10000
    buffer_load_dwordx4 v224, s[4:7], s78 offen lds
    v_mfma_f32_32x32x16_bf16 v[52:67], v[20:23], v[28:31], v[52:67]
    ds_read_b128 v[20:23], v234 offset:32768
    ds_read_b128 v[24:27], v246 offset:32768
    ds_read_b128 v[28:31], v246 offset:40960
    s_waitcnt lgkmcnt(3)
    v_mfma_f32_32x32x16_bf16 v[36:51], v[4:7], v[8:11], v[36:51]
    s_add_u32 m0, s76, 0xc000
    s_mul_i32 s78, s64, 0x80
    buffer_load_dwordx4 v225, s[8:11], s78 offen lds
    v_mfma_f32_32x32x16_bf16 v[52:67], v[4:7], v[12:15], v[52:67]
    ds_read_b128 v[4:7], v235 offset:32768
    ds_read_b128 v[8:11], v247 offset:32768
    ds_read_b128 v[12:15], v247 offset:40960
    s_waitcnt lgkmcnt(3)
    v_mfma_f32_32x32x16_bf16 v[36:51], v[20:23], v[24:27], v[36:51]
    s_add_u32 m0, s76, 0xe000
    s_mul_i32 s78, s64, 0x80
    buffer_load_dwordx4 v225, s[12:15], s78 offen lds
    v_mfma_f32_32x32x16_bf16 v[52:67], v[20:23], v[28:31], v[52:67]
    ds_read_b128 v[20:23], v236 offset:32768
    ds_read_b128 v[24:27], v248 offset:32768
    ds_read_b128 v[28:31], v248 offset:40960
    s_waitcnt lgkmcnt(3)
    v_mfma_f32_32x32x16_bf16 v[36:51], v[4:7], v[8:11], v[36:51]
    v_mfma_f32_32x32x16_bf16 v[52:67], v[4:7], v[12:15], v[52:67]
    s_waitcnt vmcnt(8)
    s_barrier
    ds_read_b128 v[4:7], v237 offset:0
    ds_read_b128 v[8:11], v249 offset:0
    ds_read_b128 v[12:15], v249 offset:8192
    s_add_u32 m0, s76, 0x10000
    s_mul_i32 s78, s65, 0x80
    buffer_load_dwordx4 v224, s[4:7], s78 offen lds
    buffer_load_dwordx2 v[220:221], v254, s[20:23], 0 offen sc1
    s_cmp_lg_u32 s61, s68
    s_cbranch_scc1 KA_XG3
    v_xor_b32 v214, 0x10000, v178
    ds_read_u16 v148, v214 offset:32768
    v_xor_b32 v215, 0x10080, v178
    ds_read_u16 v149, v215 offset:32768
    v_xor_b32 v216, 0x10010, v178
    ds_read_u16 v150, v216 offset:33024
    v_xor_b32 v217, 0x10090, v178
    ds_read_u16 v151, v217 offset:33024
    v_xor_b32 v214, 0x10040, v178
    ds_read_u16 v152, v214 offset:33792
    v_xor_b32 v215, 0x100c0, v178
    ds_read_u16 v153, v215 offset:33792
    v_xor_b32 v216, 0x10050, v178
    ds_read_u16 v154, v216 offset:34048
    v_xor_b32 v217, 0x100d0, v178
    ds_read_u16 v155, v217 offset:34048
    v_xor_b32 v214, 0x10080, v178
    ds_read_u16 v156, v214 offset:34816
    v_xor_b32 v215, 0x10000, v178
    ds_read_u16 v157, v215 offset:34816
    v_xor_b32 v216, 0x10090, v178
    ds_read_u16 v158, v216 offset:35072
    v_xor_b32 v217, 0x10010, v178
    ds_read_u16 v159, v217 offset:35072
    v_xor_b32 v214, 0x100c0, v178
    ds_read_u16 v160, v214 offset:35840
    v_xor_b32 v215, 0x10040, v178
    ds_read_u16 v161, v215 offset:35840
    v_xor_b32 v216, 0x100d0, v178
    ds_read_u16 v162, v216 offset:36096
    v_xor_b32 v217, 0x10050, v178
    ds_read_u16 v163, v217 offset:36096
    s_waitcnt lgkmcnt(0)
KA_XG3:
    s_nop 1
    s_waitcnt lgkmcnt(3)
    v_mfma_f32_32x32x16_bf16 v[36:51], v[20:23], v[24:27], v[36:51]
    s_add_u32 m0, s76, 0x12000
    s_mul_i32 s78, s65, 0x80
    s_add_u32 s78, s78, 0x10000
    buffer_load_dwordx4 v224, s[4:7], s78 offen lds
    v_mfma_f32_32x32x16_bf16 v[52:67], v[20:23], v[28:31], v[52:67]
    ds_read_b128 v[20:23], v238 offset:0
    ds_read_b128 v[24:27], v250 offset:0
    ds_read_b128 v[28:31], v250 offset:8192
    s_waitcnt lgkmcnt(3)
    v_mfma_f32_32x32x16_bf16 v[36:51], v[4:7], v[8:11], v[36:51]
    s_add_u32 m0, s76, 0x14000
    s_mul_i32 s78, s65, 0x80
    buffer_load_dwordx4 v225, s[8:11], s78 offen lds
    v_mfma_f32_32x32x16_bf16 v[52:67], v[4:7], v[12:15], v[52:67]
    ds_read_b128 v[4:7], v239 offset:0
    ds_read_b128 v[8:11], v251 offset:0
    ds_read_b128 v[12:15], v251 offset:8192
    s_waitcnt lgkmcnt(3)
    v_mfma_f32_32x32x16_bf16 v[36:51], v[20:23], v[24:27], v[36:51]
    s_add_u32 m0, s76, 0x16000
    s_mul_i32 s78, s65, 0x80
    buffer_load_dwordx4 v225, s[12:15], s78 offen lds
    v_mfma_f32_32x32x16_bf16 v[52:67], v[20:23], v[28:31], v[52:67]
    ds_read_b128 v[20:23], v240 offset:0
    ds_read_b128 v[24:27], v252 offset:0
    ds_read_b128 v[28:31], v252 offset:8192
    s_waitcnt lgkmcnt(3)
    v_mfma_f32_32x32x16_bf16 v[36:51], v[4:7], v[8:11], v[36:51]
    v_mfma_f32_32x32x16_bf16 v[52:67], v[4:7], v[12:15], v[52:67]
    s_waitcnt vmcnt(9)
    s_barrier
    ds_read_b128 v[4:7], v229 offset:0
    ds_read_b128 v[8:11], v241 offset:0
    ds_read_b128 v[12:15], v241 offset:8192
    s_add_u32 m0, s76, 0x18000
    s_mul_i32 s78, s42, 0x80
    buffer_load_dwordx4 v225, s[28:31], s78 offen lds
    s_cmp_lg_u32 s62, s68
    s_cbranch_scc1 KA_XG4
    v_xor_b32 v214, 0x20000, v178
    ds_read_u16 v148, v214 offset:0
    v_xor_b32 v215, 0x20080, v178
    ds_read_u16 v149, v215 offset:0
    v_xor_b32 v216, 0x20010, v178
    ds_read_u16 v150, v216 offset:256
    v_xor_b32 v217, 0x20090, v178
    ds_read_u16 v151, v217 offset:256
    v_xor_b32 v214, 0x20040, v178
    ds_read_u16 v152, v214 offset:1024
    v_xor_b32 v215, 0x200c0, v178
    ds_read_u16 v153, v215 offset:1024
    v_xor_b32 v216, 0x20050, v178
    ds_read_u16 v154, v216 offset:1280
    v_xor_b32 v217, 0x200d0, v178
    ds_read_u16 v155, v217 offset:1280
    v_xor_b32 v214, 0x20080, v178
    ds_read_u16 v156, v214 offset:2048
    v_xor_b32 v215, 0x20000, v178
    ds_read_u16 v157, v215 offset:2048
    v_xor_b32 v216, 0x20090, v178
    ds_read_u16 v158, v216 offset:2304
    v_xor_b32 v217, 0x20010, v178
    ds_read_u16 v159, v217 offset:2304
    v_xor_b32 v214, 0x200c0, v178
    ds_read_u16 v160, v214 offset:3072
    v_xor_b32 v215, 0x20040, v178
    ds_read_u16 v161, v215 offset:3072
    v_xor_b32 v216, 0x200d0, v178
    ds_read_u16 v162, v216 offset:3328
    v_xor_b32 v217, 0x20050, v178
    ds_read_u16 v163, v217 offset:3328
    s_waitcnt lgkmcnt(0)
KA_XG4:
    s_nop 1
    s_waitcnt lgkmcnt(3)
    v_mfma_f32_32x32x16_bf16 v[36:51], v[20:23], v[24:27], v[36:51]
    s_add_u32 m0, s76, 0x1a000
    s_mul_i32 s78, s42, 0x80
    buffer_load_dwordx4 v225, s[32:35], s78 offen lds
    v_mfma_f32_32x32x16_bf16 v[52:67], v[20:23], v[28:31], v[52:67]
    ds_read_b128 v[20:23], v230 offset:0
    ds_read_b128 v[24:27], v242 offset:0
    ds_read_b128 v[28:31], v242 offset:8192
    s_waitcnt lgkmcnt(3)
    v_mfma_f32_32x32x16_bf16 v[36:51], v[4:7], v[8:11], v[36:51]
    s_add_u32 m0, s76, 0x1c000
    s_mul_i32 s78, s43, 0x80
    buffer_load_dwordx4 v225, s[28:31], s78 offen lds
    v_mfma_f32_32x32x16_bf16 v[52:67], v[4:7], v[12:15], v[52:67]
    ds_read_b128 v[4:7], v231 offset:0
    ds_read_b128 v[8:11], v243 offset:0
    ds_read_b128 v[12:15], v243 offset:8192
    s_waitcnt lgkmcnt(3)
    v_mfma_f32_32x32x16_bf16 v[36:51], v[20:23], v[24:27], v[36:51]
    s_add_u32 m0, s76, 0x1e000
    s_mul_i32 s78, s44, 0x80
    buffer_load_dwordx4 v225, s[28:31], s78 offen lds
    v_mfma_f32_32x32x16_bf16 v[52:67], v[20:23], v[28:31], v[52:67]
    ds_read_b128 v[20:23], v232 offset:0
    ds_read_b128 v[24:27], v244 offset:0
    ds_read_b128 v[28:31], v244 offset:8192
    s_waitcnt lgkmcnt(3)
    v_mfma_f32_32x32x16_bf16 v[36:51], v[4:7], v[8:11], v[36:51]
    v_mfma_f32_32x32x16_bf16 v[52:67], v[4:7], v[12:15], v[52:67]
    s_waitcnt vmcnt(9)
    s_barrier
    ds_read_b128 v[4:7], v229 offset:32768
    ds_read_b128 v[8:11], v241 offset:32768
    ds_read_b128 v[12:15], v241 offset:40960
    s_add_u32 m0, s76, 0x20000
    s_mul_i32 s78, s45, 0x80
    buffer_load_dwordx4 v225, s[28:31], s78 offen lds
    s_cmp_lg_u32 s63, s68
    s_cbranch_scc1 KA_XG5
    v_xor_b32 v214, 0x0, v178
    ds_read_u16 v148, v214 offset:0
    v_xor_b32 v215, 0x80, v178
    ds_read_u16 v149, v215 offset:0
    v_xor_b32 v216, 0x10, v178
    ds_read_u16 v150, v216 offset:256
    v_xor_b32 v217, 0x90, v178
    ds_read_u16 v151, v217 offset:256
    v_xor_b32 v214, 0x40, v178
    ds_read_u16 v152, v214 offset:1024
    v_xor_b32 v215, 0xc0, v178
    ds_read_u16 v153, v215 offset:1024
    v_xor_b32 v216, 0x50, v178
    ds_read_u16 v154, v216 offset:1280
    v_xor_b32 v217, 0xd0, v178
    ds_read_u16 v155, v217 offset:1280
    v_xor_b32 v214, 0x80, v178
    ds_read_u16 v156, v214 offset:2048
    v_xor_b32 v215, 0x0, v178
    ds_read_u16 v157, v215 offset:2048
    v_xor_b32 v216, 0x90, v178
    ds_read_u16 v158, v216 offset:2304
    v_xor_b32 v217, 0x10, v178
    ds_read_u16 v159, v217 offset:2304
    v_xor_b32 v214, 0xc0, v178
    ds_read_u16 v160, v214 offset:3072
    v_xor_b32 v215, 0x40, v178
    ds_read_u16 v161, v215 offset:3072
    v_xor_b32 v216, 0xd0, v178
    ds_read_u16 v162, v216 offset:3328
    v_xor_b32 v217, 0x50, v178
    ds_read_u16 v163, v217 offset:3328
    s_waitcnt lgkmcnt(0)
KA_XG5:
    s_nop 1
    s_waitcnt lgkmcnt(3)
    v_mfma_f32_32x32x16_bf16 v[36:51], v[20:23], v[24:27], v[36:51]
    s_add_u32 m0, s76, 0x22000
    s_mul_i32 s78, s46, 0x80
    buffer_load_dwordx4 v225, s[28:31], s78 offen lds
    v_mfma_f32_32x32x16_bf16 v[52:67], v[20:23], v[28:31], v[52:67]
    ds_read_b128 v[20:23], v230 offset:32768
    ds_read_b128 v[24:27], v242 offset:32768
    ds_read_b128 v[28:31], v242 offset:40960
    s_waitcnt lgkmcnt(3)
    v_mfma_f32_32x32x16_bf16 v[36:51], v[4:7], v[8:11], v[36:51]
    s_add_u32 m0, s76, 0x24000
    s_mul_i32 s78, s47, 0x80
    buffer_load_dwordx4 v225, s[28:31], s78 offen lds
    v_mfma_f32_32x32x16_bf16 v[52:67], v[4:7], v[12:15], v[52:67]
    ds_read_b128 v[4:7], v231 offset:32768
    ds_read_b128 v[8:11], v243 offset:32768
    ds_read_b128 v[12:15], v243 offset:40960
    s_waitcnt lgkmcnt(3)
    v_mfma_f32_32x32x16_bf16 v[36:51], v[20:23], v[24:27], v[36:51]
    s_add_u32 m0, s76, 0x26000
    s_mul_i32 s78, s48, 0x80
    buffer_load_dwordx4 v225, s[28:31], s78 offen lds
    v_mfma_f32_32x32x16_bf16 v[52:67], v[20:23], v[28:31], v[52:67]
    ds_read_b128 v[20:23], v232 offset:32768
    ds_read_b128 v[24:27], v244 offset:32768
    ds_read_b128 v[28:31], v244 offset:40960
    s_waitcnt lgkmcnt(3)
    v_mfma_f32_32x32x16_bf16 v[36:51], v[4:7], v[8:11], v[36:51]
    v_mfma_f32_32x32x16_bf16 v[52:67], v[4:7], v[12:15], v[52:67]
    s_waitcnt vmcnt(8)
    s_barrier
    ds_read_b128 v[4:7], v233 offset:0
    ds_read_b128 v[8:11], v245 offset:0
    ds_read_b128 v[12:15], v245 offset:8192
    s_add_u32 m0, s76, 0x2000
    s_mul_i32 s78, s48, 0x80
    buffer_load_dwordx4 v225, s[32:35], s78 offen lds
    s_cmp_lg_u32 s64, s68
    s_cbranch_scc1 KA_XG6
    v_xor_b32 v214, 0x0, v178
    ds_read_u16 v148, v214 offset:32768
    v_xor_b32 v215, 0x80, v178
    ds_read_u16 v149, v215 offset:32768
    v_xor_b32 v216, 0x10, v178
    ds_read_u16 v150, v216 offset:33024
    v_xor_b32 v217, 0x90, v178
    ds_read_u16 v151, v217 offset:33024
    v_xor_b32 v214, 0x40, v178
    ds_read_u16 v152, v214 offset:33792
    v_xor_b32 v215, 0xc0, v178
    ds_read_u16 v153, v215 offset:33792
    v_xor_b32 v216, 0x50, v178
    ds_read_u16 v154, v216 offset:34048
    v_xor_b32 v217, 0xd0, v178
    ds_read_u16 v155, v217 offset:34048
    v_xor_b32 v214, 0x80, v178
    ds_read_u16 v156, v214 offset:34816
    v_xor_b32 v215, 0x0, v178
    ds_read_u16 v157, v215 offset:34816
    v_xor_b32 v216, 0x90, v178
    ds_read_u16 v158, v216 offset:35072
    v_xor_b32 v217, 0x10, v178
    ds_read_u16 v159, v217 offset:35072
    v_xor_b32 v214, 0xc0, v178
    ds_read_u16 v160, v214 offset:35840
    v_xor_b32 v215, 0x40, v178
    ds_read_u16 v161, v215 offset:35840
    v_xor_b32 v216, 0xd0, v178
    ds_read_u16 v162, v216 offset:36096
    v_xor_b32 v217, 0x50, v178
    ds_read_u16 v163, v217 offset:36096
    s_waitcnt lgkmcnt(0)
KA_XG6:
    s_nop 1
    s_waitcnt lgkmcnt(3)
    v_mfma_f32_32x32x16_bf16 v[36:51], v[20:23], v[24:27], v[36:51]
    v_mfma_f32_32x32x16_bf16 v[52:67], v[20:23], v[28:31], v[52:67]
    ds_read_b128 v[20:23], v234 offset:0
    ds_read_b128 v[24:27], v246 offset:0
    ds_read_b128 v[28:31], v246 offset:8192
    s_waitcnt lgkmcnt(3)
    v_mfma_f32_32x32x16_bf16 v[36:51], v[4:7], v[8:11], v[36:51]
    v_mfma_f32_32x32x16_bf16 v[52:67], v[4:7], v[12:15], v[52:67]
    ds_read_b128 v[4:7], v235 offset:0
    ds_read_b128 v[8:11], v247 offset:0
    ds_read_b128 v[12:15], v247 offset:8192
    s_waitcnt lgkmcnt(3)
    v_mfma_f32_32x32x16_bf16 v[36:51], v[20:23], v[24:27], v[36:51]
    v_mfma_f32_32x32x16_bf16 v[52:67], v[20:23], v[28:31], v[52:67]
    ds_read_b128 v[20:23], v236 offset:0
    ds_read_b128 v[24:27], v248 offset:0
    ds_read_b128 v[28:31], v248 offset:8192
    s_waitcnt lgkmcnt(3)
    v_mfma_f32_32x32x16_bf16 v[36:51], v[4:7], v[8:11], v[36:51]
    v_mfma_f32_32x32x16_bf16 v[52:67], v[4:7], v[12:15], v[52:67]
    s_barrier
    s_add_u32 m0, s76, 0xc000
    s_mul_i32 s78, s49, 0x80
    buffer_load_dwordx4 v225, s[28:31], s78 offen lds
    s_cmp_lg_u32 s65, s68
    s_cbranch_scc1 KA_XG7
    v_xor_b32 v214, 0x10000, v178
    ds_read_u16 v148, v214 offset:0
    v_xor_b32 v215, 0x10080, v178
    ds_read_u16 v149, v215 offset:0
    v_xor_b32 v216, 0x10010, v178
    ds_read_u16 v150, v216 offset:256
    v_xor_b32 v217, 0x10090, v178
    ds_read_u16 v151, v217 offset:256
    v_xor_b32 v214, 0x10040, v178
    ds_read_u16 v152, v214 offset:1024
    v_xor_b32 v215, 0x100c0, v178
    ds_read_u16 v153, v215 offset:1024
    v_xor_b32 v216, 0x10050, v178
    ds_read_u16 v154, v216 offset:1280
    v_xor_b32 v217, 0x100d0, v178
    ds_read_u16 v155, v217 offset:1280
    v_xor_b32 v214, 0x10080, v178
    ds_read_u16 v156, v214 offset:2048
    v_xor_b32 v215, 0x10000, v178
    ds_read_u16 v157, v215 offset:2048
    v_xor_b32 v216, 0x10090, v178
    ds_read_u16 v158, v216 offset:2304
    v_xor_b32 v217, 0x10010, v178
    ds_read_u16 v159, v217 offset:2304
    v_xor_b32 v214, 0x100c0, v178
    ds_read_u16 v160, v214 offset:3072
    v_xor_b32 v215, 0x10040, v178
    ds_read_u16 v161, v215 offset:3072
    v_xor_b32 v216, 0x100d0, v178
    ds_read_u16 v162, v216 offset:3328
    v_xor_b32 v217, 0x10050, v178
    ds_read_u16 v163, v217 offset:3328
    s_waitcnt lgkmcnt(0)
KA_XG7:
    s_nop 1
    s_waitcnt lgkmcnt(0)
    v_mfma_f32_32x32x16_bf16 v[36:51], v[20:23], v[24:27], v[36:51]
    s_add_u32 m0, s76, 0xe000
    s_mul_i32 s78, s43, 0x80
    buffer_load_dwordx4 v225, s[32:35], s78 offen lds
    v_mfma_f32_32x32x16_bf16 v[52:67], v[20:23], v[28:31], v[52:67]
    s_lshl_b32 s73, s71, 8
    s_add_u32 s73, s73, 0x0
    v_lshl_add_u32 v215, v2, 3, s73
    s_lshl_b32 s74, s70, 9
    v_add_u32 v214, s74, v215
    s_lshl_b32 s74, s68, 14
    s_lshl_b32 s73, s71, 9
    s_add_u32 s74, s74, s73
    s_add_u32 s74, s74, 0x600000
    v_lshl_add_u32 v216, v2, 4, s74
    v_pk_fma_f32 v[92:93], v[182:183], v[36:37], v[38:39] op_sel_hi:[0,1,1]
    s_nop 0
    v_pk_fma_f32 v[94:95], v[182:183], v[52:53], v[54:55] op_sel_hi:[0,1,1]
    v_pk_fma_f32 v[92:93], v[182:183], v[52:53], v[92:93] op_sel:[1,0,0] op_sel_hi:[1,1,1] neg_lo:[1,0,0] neg_hi:[1,0,0]
    v_pk_fma_f32 v[94:95], v[182:183], v[36:37], v[94:95] op_sel:[1,0,0] op_sel_hi:[1,1,1]
    v_pk_fma_f32 v[88:89], v[174:175], v[92:93], v[40:41] op_sel_hi:[0,1,1]
    v_pk_fma_f32 v[90:91], v[174:175], v[94:95], v[56:57] op_sel_hi:[0,1,1]
    v_pk_fma_f32 v[88:89], v[174:175], v[94:95], v[88:89] op_sel:[1,0,0] op_sel_hi:[1,1,1] neg_lo:[1,0,0] neg_hi:[1,0,0]
    v_pk_fma_f32 v[90:91], v[174:175], v[92:93], v[90:91] op_sel:[1,0,0] op_sel_hi:[1,1,1]
    v_pk_fma_f32 v[92:93], v[182:183], v[88:89], v[42:43] op_sel_hi:[0,1,1]
    v_pk_fma_f32 v[94:95], v[182:183], v[90:91], v[58:59] op_sel_hi:[0,1,1]
    v_pk_fma_f32 v[92:93], v[182:183], v[90:91], v[92:93] op_sel:[1,0,0] op_sel_hi:[1,1,1] neg_lo:[1,0,0] neg_hi:[1,0,0]
    v_pk_fma_f32 v[94:95], v[182:183], v[88:89], v[94:95] op_sel:[1,0,0] op_sel_hi:[1,1,1]
    v_pk_fma_f32 v[88:89], v[174:175], v[92:93], v[44:45] op_sel_hi:[0,1,1]
    v_pk_fma_f32 v[90:91], v[174:175], v[94:95], v[60:61] op_sel_hi:[0,1,1]
    v_pk_fma_f32 v[88:89], v[174:175], v[94:95], v[88:89] op_sel:[1,0,0] op_sel_hi:[1,1,1] neg_lo:[1,0,0] neg_hi:[1,0,0]
    v_pk_fma_f32 v[90:91], v[174:175], v[92:93], v[90:91] op_sel:[1,0,0] op_sel_hi:[1,1,1]
    v_pk_fma_f32 v[92:93], v[182:183], v[88:89], v[46:47] op_sel_hi:[0,1,1]
    v_pk_fma_f32 v[94:95], v[182:183], v[90:91], v[62:63] op_sel_hi:[0,1,1]
    v_pk_fma_f32 v[92:93], v[182:183], v[90:91], v[92:93] op_sel:[1,0,0] op_sel_hi:[1,1,1] neg_lo:[1,0,0] neg_hi:[1,0,0]
    v_pk_fma_f32 v[94:95], v[182:183], v[88:89], v[94:95] op_sel:[1,0,0] op_sel_hi:[1,1,1]
    v_pk_fma_f32 v[88:89], v[174:175], v[92:93], v[48:49] op_sel_hi:[0,1,1]
    v_pk_fma_f32 v[90:91], v[174:175], v[94:95], v[64:65] op_sel_hi:[0,1,1]
    v_pk_fma_f32 v[88:89], v[174:175], v[94:95], v[88:89] op_sel:[1,0,0] op_sel_hi:[1,1,1] neg_lo:[1,0,0] neg_hi:[1,0,0]
    v_pk_fma_f32 v[90:91], v[174:175], v[92:93], v[90:91] op_sel:[1,0,0] op_sel_hi:[1,1,1]
    v_pk_fma_f32 v[92:93], v[182:183], v[88:89], v[50:51] op_sel_hi:[0,1,1]
    v_pk_fma_f32 v[94:95], v[182:183], v[90:91], v[66:67] op_sel_hi:[0,1,1]
    v_pk_fma_f32 v[92:93], v[182:183], v[90:91], v[92:93] op_sel:[1,0,0] op_sel_hi:[1,1,1] neg_lo:[1,0,0] neg_hi:[1,0,0]
    v_pk_fma_f32 v[94:95], v[182:183], v[88:89], v[94:95] op_sel:[1,0,0] op_sel_hi:[1,1,1]
    v_fma_f32 v86, v180, v92, v93
    v_fma_f32 v87, v180, v94, v95
    v_fma_f32 v86, -v181, v94, v86
    v_fma_f32 v87, v181, v92, v87
    v_mov_b32 v84, v86
    v_mov_b32 v85, v87
    s_nop 0
    v_permlane32_swap_b32 v86, v84
    v_permlane32_swap_b32 v87, v85
    v_pk_fma_f32 v[84:85], v[186:187], v[86:87], v[84:85] op_sel:[0,0,0] op_sel_hi:[0,1,1]
    v_pk_fma_f32 v[84:85], v[186:187], v[86:87], v[84:85] op_sel:[1,1,0] op_sel_hi:[1,0,1] neg_lo:[1,0,0]
    ds_write_b64 v214, v[84:85]
    s_waitcnt vmcnt(14)
    v_cmp_eq_u32 vcc, 0, v220
    s_nop 2
    s_cbranch_vccz KA_NOK
    s_mov_b32 s75, 200000
KA_NRETRY:
    buffer_load_dwordx2 v[220:221], v254, s[20:23], 0 offen sc1
    s_waitcnt vmcnt(0)
    v_cmp_eq_u32 vcc, 0, v220
    s_nop 4
    s_cbranch_vccz KA_NOK
    s_sub_u32 s75, s75, 1
    s_cmp_lg_u32 s75, 0
    s_cbranch_scc1 KA_NRETRY
KA_NOK:
    s_nop 3
    s_waitcnt lgkmcnt(0)
    s_barrier
    ds_read_b64 v[92:93], v215 offset:0
    ds_read_b64 v[94:95], v215 offset:512
    ds_read_b64 v[96:97], v215 offset:1024
    ds_read_b64 v[98:99], v215 offset:1536
    v_mov_b32 v6, v220
    v_mov_b32 v7, v221
    s_lshl_b32 s73, s67, 10
    s_waitcnt lgkmcnt(0)
    v_pk_fma_f32 v[88:89], v[188:189], v[92:93], v[94:95] op_sel:[0,0,0] op_sel_hi:[0,1,1]
    v_pk_fma_f32 v[88:89], v[188:189], v[92:93], v[88:89] op_sel:[1,1,0] op_sel_hi:[1,0,1] neg_lo:[1,0,0]
    v_pk_fma_f32 v[90:91], v[188:189], v[88:89], v[96:97] op_sel:[0,0,0] op_sel_hi:[0,1,1]
    v_pk_fma_f32 v[90:91], v[188:189], v[88:89], v[90:91] op_sel:[1,1,0] op_sel_hi:[1,0,1] neg_lo:[1,0,0]
    s_cmp_lg_u32 s70, 0
    s_cbranch_scc1 KA_NOPUB
    v_pk_fma_f32 v[4:5], v[188:189], v[90:91], v[98:99] op_sel:[0,0,0] op_sel_hi:[0,1,1]
    v_pk_fma_f32 v[4:5], v[188:189], v[90:91], v[4:5] op_sel:[1,1,0] op_sel_hi:[1,0,1] neg_lo:[1,0,0]
    buffer_store_dwordx4 v[4:7], v216, s[16:19], s73 offen sc1
KA_NOPUB:
    s_nop 3
    s_add_u32 m0, s76, 0x10000
    s_mul_i32 s78, s44, 0x80
    buffer_load_dwordx4 v225, s[32:35], s78 offen lds
    v_mov_b32 v108, 0
    v_mov_b32 v109, 0
    s_cmp_eq_u32 s70, 1
    s_cselect_b64 s[80:81], -1, 0
    v_cndmask_b32 v108, v108, v92, s[80:81]
    v_cndmask_b32 v109, v109, v93, s[80:81]
    s_cmp_eq_u32 s70, 2
    s_cselect_b64 s[80:81], -1, 0
    v_cndmask_b32 v108, v108, v88, s[80:81]
    v_cndmask_b32 v109, v109, v89, s[80:81]
    s_cmp_eq_u32 s70, 3
    s_cselect_b64 s[80:81], -1, 0
    v_cndmask_b32 v108, v108, v90, s[80:81]
    v_cndmask_b32 v109, v109, v91, s[80:81]
    v_pk_mul_f32 v[212:213], v[192:193], v[108:109] op_sel:[0,0] op_sel_hi:[0,1]
    v_pk_fma_f32 v[212:213], v[192:193], v[108:109], v[212:213] op_sel:[1,1,0] op_sel_hi:[1,0,1] neg_lo:[1,0,0]
    s_add_u32 m0, s76, 0x12000
    s_mul_i32 s78, s45, 0x80
    buffer_load_dwordx4 v225, s[32:35], s78 offen lds
    v_mul_f32 v68, v192, v36
    v_fma_f32 v68, -v193, v52, v68
    v_mul_f32 v52, v192, v52
    v_fma_f32 v52, v193, v36, v52
    v_mul_f32 v69, v192, v37
    v_fma_f32 v69, -v193, v53, v69
    v_mul_f32 v53, v192, v53
    v_fma_f32 v53, v193, v37, v53
    v_mul_f32 v70, v192, v38
    v_fma_f32 v70, -v193, v54, v70
    v_mul_f32 v54, v192, v54
    v_fma_f32 v54, v193, v38, v54
    v_mul_f32 v71, v192, v39
    v_fma_f32 v71, -v193, v55, v71
    v_mul_f32 v55, v192, v55
    v_fma_f32 v55, v193, v39, v55
    v_mul_f32 v72, v192, v40
    v_fma_f32 v72, -v193, v56, v72
    v_mul_f32 v56, v192, v56
    v_fma_f32 v56, v193, v40, v56
    v_mul_f32 v73, v192, v41
    v_fma_f32 v73, -v193, v57, v73
    v_mul_f32 v57, v192, v57
    v_fma_f32 v57, v193, v41, v57
    s_add_u32 m0, s76, 0x14000
    s_mul_i32 s78, s46, 0x80
    buffer_load_dwordx4 v225, s[32:35], s78 offen lds
    v_mul_f32 v74, v192, v42
    v_fma_f32 v74, -v193, v58, v74
    v_mul_f32 v58, v192, v58
    v_fma_f32 v58, v193, v42, v58
    v_mul_f32 v75, v192, v43
    v_fma_f32 v75, -v193, v59, v75
    v_mul_f32 v59, v192, v59
    v_fma_f32 v59, v193, v43, v59
    v_mul_f32 v76, v192, v44
    v_fma_f32 v76, -v193, v60, v76
    v_mul_f32 v60, v192, v60
    v_fma_f32 v60, v193, v44, v60
    v_mul_f32 v77, v192, v45
    v_fma_f32 v77, -v193, v61, v77
    v_mul_f32 v61, v192, v61
    v_fma_f32 v61, v193, v45, v61
    v_mul_f32 v78, v192, v46
    v_fma_f32 v78, -v193, v62, v78
    v_mul_f32 v62, v192, v62
    v_fma_f32 v62, v193, v46, v62
    v_mul_f32 v79, v192, v47
    v_fma_f32 v79, -v193, v63, v79
    v_mul_f32 v63, v192, v63
    v_fma_f32 v63, v193, v47, v63
    s_add_u32 m0, s76, 0x16000
    s_mul_i32 s78, s47, 0x80
    buffer_load_dwordx4 v225, s[32:35], s78 offen lds
    v_mul_f32 v80, v192, v48
    v_fma_f32 v80, -v193, v64, v80
    v_mul_f32 v64, v192, v64
    v_fma_f32 v64, v193, v48, v64
    v_mul_f32 v81, v192, v49
    v_fma_f32 v81, -v193, v65, v81
    v_mul_f32 v65, v192, v65
    v_fma_f32 v65, v193, v49, v65
    v_mul_f32 v82, v192, v50
    v_fma_f32 v82, -v193, v66, v82
    v_mul_f32 v66, v192, v66
    v_fma_f32 v66, v193, v50, v66
    v_mul_f32 v83, v192, v51
    v_fma_f32 v83, -v193, v67, v83
    v_mul_f32 v67, v192, v67
    v_fma_f32 v67, v193, v51, v67
    s_cmp_eq_u32 s67, 0
    s_cbranch_scc1 KA_E0
    buffer_load_dwordx4 v[100:103], v170, s[16:19], 0 offen sc1
    buffer_load_dwordx4 v[104:107], v171, s[16:19], 0 offen sc1
KA_E0:
    s_nop 1
    v_fma_f32 v69, v180, v68, v69
    v_fma_f32 v53, v180, v52, v53
    v_fma_f32 v69, -v181, v52, v69
    v_fma_f32 v53, v181, v68, v53
    v_fma_f32 v73, v180, v72, v73
    v_fma_f32 v57, v180, v56, v57
    v_fma_f32 v73, -v181, v56, v73
    v_fma_f32 v57, v181, v72, v57
    v_fma_f32 v77, v180, v76, v77
    v_fma_f32 v61, v180, v60, v61
    v_fma_f32 v77, -v181, v60, v77
    v_fma_f32 v61, v181, v76, v61
    v_fma_f32 v81, v180, v80, v81
    v_fma_f32 v65, v180, v64, v65
    v_fma_f32 v81, -v181, v64, v81
    v_fma_f32 v65, v181, v80, v65
    v_fma_f32 v70, v180, v69, v70
    v_fma_f32 v54, v180, v53, v54
    v_fma_f32 v70, -v181, v53, v70
    v_fma_f32 v54, v181, v69, v54
    v_fma_f32 v74, v180, v73, v74
    v_fma_f32 v58, v180, v57, v58
    v_fma_f32 v74, -v181, v57, v74
    v_fma_f32 v58, v181, v73, v58
    v_fma_f32 v78, v180, v77, v78
    v_fma_f32 v62, v180, v61, v62
    v_fma_f32 v78, -v181, v61, v78
    v_fma_f32 v62, v181, v77, v62
    v_fma_f32 v82, v180, v81, v82
    v_fma_f32 v66, v180, v65, v66
    v_fma_f32 v82, -v181, v65, v82
    v_fma_f32 v66, v181, v81, v66
    v_fma_f32 v71, v180, v70, v71
    v_fma_f32 v55, v180, v54, v55
    v_fma_f32 v71, -v181, v54, v71
    v_fma_f32 v55, v181, v70, v55
    v_fma_f32 v75, v180, v74, v75
    v_fma_f32 v59, v180, v58, v59
    v_fma_f32 v75, -v181, v58, v75
    v_fma_f32 v59, v181, v74, v59
    v_fma_f32 v79, v180, v78, v79
    v_fma_f32 v63, v180, v62, v63
    v_fma_f32 v79, -v181, v62, v79
    v_fma_f32 v63, v181, v78, v63
    v_fma_f32 v83, v180, v82, v83
    v_fma_f32 v67, v180, v66, v67
    v_fma_f32 v83, -v181, v66, v83
    v_fma_f32 v67, v181, v82, v67
    v_mov_b32 v8, v71
    v_mov_b32 v16, v71
    v_mov_b32 v9, v55
    v_mov_b32 v17, v55
    v_mov_b32 v10, v75
    v_mov_b32 v18, v75
    v_mov_b32 v11, v59
    v_mov_b32 v19, v59
    v_mov_b32 v12, v79
    v_mov_b32 v20, v79
    v_mov_b32 v13, v63
    v_mov_b32 v21, v63
    v_mov_b32 v14, v83
    v_mov_b32 v22, v83
    v_mov_b32 v15, v67
    v_mov_b32 v23, v67
    v_permlane32_swap_b32 v8, v16
    v_permlane32_swap_b32 v9, v17
    v_permlane32_swap_b32 v10, v18
    v_permlane32_swap_b32 v11, v19
    v_permlane32_swap_b32 v12, v20
    v_permlane32_swap_b32 v13, v21
    v_permlane32_swap_b32 v14, v22
    v_permlane32_swap_b32 v15, v23
    v_mov_b32 v26, v8
    v_mov_b32 v27, v9
    v_cndmask_b32 v204, v254, v26, s[82:83]
    v_cndmask_b32 v205, v254, v27, s[82:83]
    v_pk_fma_f32 v[24:25], v[186:187], v[26:27], v[16:17] op_sel:[0,0,0] op_sel_hi:[0,1,1]
    v_pk_fma_f32 v[24:25], v[186:187], v[26:27], v[24:25] op_sel:[1,1,0] op_sel_hi:[1,0,1] neg_lo:[1,0,0]
    v_pk_fma_f32 v[26:27], v[186:187], v[24:25], v[10:11] op_sel:[0,0,0] op_sel_hi:[0,1,1]
    v_pk_fma_f32 v[26:27], v[186:187], v[24:25], v[26:27] op_sel:[1,1,0] op_sel_hi:[1,0,1] neg_lo:[1,0,0]
    v_cndmask_b32 v206, v24, v26, s[82:83]
    v_cndmask_b32 v207, v25, v27, s[82:83]
    v_pk_fma_f32 v[24:25], v[186:187], v[26:27], v[18:19] op_sel:[0,0,0] op_sel_hi:[0,1,1]
    v_pk_fma_f32 v[24:25], v[186:187], v[26:27], v[24:25] op_sel:[1,1,0] op_sel_hi:[1,0,1] neg_lo:[1,0,0]
    v_pk_fma_f32 v[26:27], v[186:187], v[24:25], v[12:13] op_sel:[0,0,0] op_sel_hi:[0,1,1]
    v_pk_fma_f32 v[26:27], v[186:187], v[24:25], v[26:27] op_sel:[1,1,0] op_sel_hi:[1,0,1] neg_lo:[1,0,0]
    v_cndmask_b32 v208, v24, v26, s[82:83]
    v_cndmask_b32 v209, v25, v27, s[82:83]
    v_pk_fma_f32 v[24:25], v[186:187], v[26:27], v[20:21] op_sel:[0,0,0] op_sel_hi:[0,1,1]
    v_pk_fma_f32 v[24:25], v[186:187], v[26:27], v[24:25] op_sel:[1,1,0] op_sel_hi:[1,0,1] neg_lo:[1,0,0]
    v_pk_fma_f32 v[26:27], v[186:187], v[24:25], v[14:15] op_sel:[0,0,0] op_sel_hi:[0,1,1]
    v_pk_fma_f32 v[26:27], v[186:187], v[24:25], v[26:27] op_sel:[1,1,0] op_sel_hi:[1,0,1] neg_lo:[1,0,0]
    v_cndmask_b32 v210, v24, v26, s[82:83]
    v_cndmask_b32 v211, v25, v27, s[82:83]
    v_pk_fma_f32 v[204:205], v[196:197], v[212:213], v[204:205] op_sel:[0,0,0] op_sel_hi:[0,1,1]
    v_pk_fma_f32 v[204:205], v[196:197], v[212:213], v[204:205] op_sel:[1,1,0] op_sel_hi:[1,0,1] neg_lo:[1,0,0]
    v_pk_fma_f32 v[206:207], v[198:199], v[212:213], v[206:207] op_sel:[0,0,0] op_sel_hi:[0,1,1]
    v_pk_fma_f32 v[206:207], v[198:199], v[212:213], v[206:207] op_sel:[1,1,0] op_sel_hi:[1,0,1] neg_lo:[1,0,0]
    v_pk_fma_f32 v[208:209], v[200:201], v[212:213], v[208:209] op_sel:[0,0,0] op_sel_hi:[0,1,1]
    v_pk_fma_f32 v[208:209], v[200:201], v[212:213], v[208:209] op_sel:[1,1,0] op_sel_hi:[1,0,1] neg_lo:[1,0,0]
    v_pk_fma_f32 v[210:211], v[202:203], v[212:213], v[210:211] op_sel:[0,0,0] op_sel_hi:[0,1,1]
    v_pk_fma_f32 v[210:211], v[202:203], v[212:213], v[210:211] op_sel:[1,1,0] op_sel_hi:[1,0,1] neg_lo:[1,0,0]
    v_lshlrev_b32 v164, 16, v164
    v_lshlrev_b32 v148, 16, v148
    v_lshlrev_b32 v149, 16, v149
    v_pk_mul_f32 v[148:149], v[148:149], v[164:165] op_sel:[0,0] op_sel_hi:[1,0]
    v_cvt_pk_bf16_f32 v149, v148, v149
    v_lshlrev_b32 v148, 16, v149
    v_and_b32 v149, 0xffff0000, v149
    v_lshlrev_b32 v150, 16, v150
    v_lshlrev_b32 v151, 16, v151
    v_pk_mul_f32 v[150:151], v[150:151], v[164:165] op_sel:[0,0] op_sel_hi:[1,0]
    v_cvt_pk_bf16_f32 v151, v150, v151
    v_lshlrev_b32 v150, 16, v151
    v_and_b32 v151, 0xffff0000, v151
    v_lshlrev_b32 v152, 16, v152
    v_lshlrev_b32 v153, 16, v153
    v_pk_mul_f32 v[152:153], v[152:153], v[164:165] op_sel:[0,0] op_sel_hi:[1,0]
    v_cvt_pk_bf16_f32 v153, v152, v153
    v_lshlrev_b32 v152, 16, v153
    v_and_b32 v153, 0xffff0000, v153
    v_lshlrev_b32 v154, 16, v154
    v_lshlrev_b32 v155, 16, v155
    v_pk_mul_f32 v[154:155], v[154:155], v[164:165] op_sel:[0,0] op_sel_hi:[1,0]
    v_cvt_pk_bf16_f32 v155, v154, v155
    v_lshlrev_b32 v154, 16, v155
    v_and_b32 v155, 0xffff0000, v155
    v_lshlrev_b32 v156, 16, v156
    v_lshlrev_b32 v157, 16, v157
    v_pk_mul_f32 v[156:157], v[156:157], v[164:165] op_sel:[0,0] op_sel_hi:[1,0]
    v_cvt_pk_bf16_f32 v157, v156, v157
    v_lshlrev_b32 v156, 16, v157
    v_and_b32 v157, 0xffff0000, v157
    v_lshlrev_b32 v158, 16, v158
    v_lshlrev_b32 v159, 16, v159
    v_pk_mul_f32 v[158:159], v[158:159], v[164:165] op_sel:[0,0] op_sel_hi:[1,0]
    v_cvt_pk_bf16_f32 v159, v158, v159
    v_lshlrev_b32 v158, 16, v159
    v_and_b32 v159, 0xffff0000, v159
    v_lshlrev_b32 v160, 16, v160
    v_lshlrev_b32 v161, 16, v161
    v_pk_mul_f32 v[160:161], v[160:161], v[164:165] op_sel:[0,0] op_sel_hi:[1,0]
    v_cvt_pk_bf16_f32 v161, v160, v161
    v_lshlrev_b32 v160, 16, v161
    v_and_b32 v161, 0xffff0000, v161
    v_lshlrev_b32 v162, 16, v162
    v_lshlrev_b32 v163, 16, v163
    v_pk_mul_f32 v[162:163], v[162:163], v[164:165] op_sel:[0,0] op_sel_hi:[1,0]
    v_cvt_pk_bf16_f32 v163, v162, v163
    v_lshlrev_b32 v162, 16, v163
    v_and_b32 v163, 0xffff0000, v163
    s_lshl_b32 s73, s71, 10
    s_add_u32 s73, s73, 0x800
    v_lshl_add_u32 v215, v2, 3, s73
    s_lshl_b32 s74, s70, 8
    v_add_u32 v214, s74, v215
    s_mov_b32 s75, 200000
    s_mov_b32 s78, 0x20000
    v_mov_b32 v28, 0
    v_mov_b32 v29, 0
    v_mov_b32 v36, v180
    v_mov_b32 v40, v181
    v_mov_b32 v37, v182
    v_mov_b32 v41, v183
    v_mov_b32 v38, v184
    v_mov_b32 v42, v185
    v_mov_b32 v39, v186
    v_mov_b32 v43, v187
    s_cmp_eq_u32 s67, 0
    s_cbranch_scc1 KA_ENC0
KA_EP:
    buffer_load_dwordx4 v[124:127], v170, s[16:19], 0 offen sc1
    buffer_load_dwordx4 v[128:131], v171, s[16:19], 0 offen sc1
    s_waitcnt vmcnt(2)
    v_xor_b32 v218, v102, v220
    v_xor_b32 v217, v103, v221
    v_xor_b32 v216, v106, v220
    v_or3_b32 v218, v218, v217, v216
    v_xor_b32 v217, v107, v221
    v_or_b32 v218, v218, v217
    v_cmp_ne_u32 vcc, 0, v218
    s_nop 2
    s_cbranch_vccz KA_EOK
    s_nop 1
    buffer_load_dwordx4 v[100:103], v170, s[16:19], 0 offen sc1
    buffer_load_dwordx4 v[104:107], v171, s[16:19], 0 offen sc1
    s_waitcnt vmcnt(2)
    v_xor_b32 v218, v126, v220
    v_xor_b32 v217, v127, v221
    v_xor_b32 v216, v130, v220
    v_or3_b32 v218, v218, v217, v216
    v_xor_b32 v217, v131, v221
    v_or_b32 v218, v218, v217
    v_cmp_ne_u32 vcc, 0, v218
    s_nop 2
    s_cbranch_vccz KA_EOK2
    s_sub_u32 s75, s75, 1
    s_cmp_lg_u32 s75, 0
    s_nop 1
    s_cbranch_scc1 KA_EP
KA_EOK2:
    s_nop 3
    v_pk_mul_f32 v[28:29], v[166:167], v[124:125] op_sel:[0,0] op_sel_hi:[0,1]
    v_pk_fma_f32 v[28:29], v[166:167], v[124:125], v[28:29] op_sel:[1,1,0] op_sel_hi:[1,0,1] neg_lo:[1,0,0]
    v_pk_fma_f32 v[28:29], v[168:169], v[128:129], v[28:29] op_sel:[0,0,0] op_sel_hi:[0,1,1]
    v_pk_fma_f32 v[28:29], v[168:169], v[128:129], v[28:29] op_sel:[1,1,0] op_sel_hi:[1,0,1] neg_lo:[1,0,0]
    s_branch KA_EOK3
KA_EOK:
    s_nop 3
    v_pk_mul_f32 v[28:29], v[166:167], v[100:101] op_sel:[0,0] op_sel_hi:[0,1]
    v_pk_fma_f32 v[28:29], v[166:167], v[100:101], v[28:29] op_sel:[1,1,0] op_sel_hi:[1,0,1] neg_lo:[1,0,0]
    v_pk_fma_f32 v[28:29], v[168:169], v[104:105], v[28:29] op_sel:[0,0,0] op_sel_hi:[0,1,1]
    v_pk_fma_f32 v[28:29], v[168:169], v[104:105], v[28:29] op_sel:[1,1,0] op_sel_hi:[1,0,1] neg_lo:[1,0,0]
KA_EOK3:
    s_nop 1
    v_mov_b32 v30, v28
    v_mov_b32 v31, v29
    s_nop 0
    v_permlane32_swap_b32 v28, v30
    v_permlane32_swap_b32 v29, v31
    v_pk_add_f32 v[28:29], v[28:29], v[30:31] op_sel:[0,0] op_sel_hi:[1,1]
    ds_write_b64 v214, v[28:29]
    s_waitcnt lgkmcnt(0)
    s_barrier
    ds_read_b64 v[132:133], v215 offset:0
    ds_read_b64 v[134:135], v215 offset:256
    ds_read_b64 v[136:137], v215 offset:512
    ds_read_b64 v[138:139], v215 offset:768
    s_waitcnt lgkmcnt(0)
    v_add_f32 v28, v132, v134
    v_add_f32 v30, v136, v138
    v_add_f32 v29, v133, v135
    v_add_f32 v31, v137, v139
    v_pk_add_f32 v[28:29], v[28:29], v[30:31] op_sel:[0,0] op_sel_hi:[1,1]
KA_ENC:
    s_nop 1
    v_pk_fma_f32 v[204:205], v[116:117], v[28:29], v[204:205] op_sel:[0,0,0] op_sel_hi:[0,1,1]
    v_pk_fma_f32 v[206:207], v[118:119], v[28:29], v[206:207] op_sel:[0,0,0] op_sel_hi:[0,1,1]
    v_pk_fma_f32 v[208:209], v[120:121], v[28:29], v[208:209] op_sel:[0,0,0] op_sel_hi:[0,1,1]
    v_pk_fma_f32 v[210:211], v[122:123], v[28:29], v[210:211] op_sel:[0,0,0] op_sel_hi:[0,1,1]
    v_pk_fma_f32 v[204:205], v[116:117], v[28:29], v[204:205] op_sel:[1,1,0] op_sel_hi:[1,0,1] neg_lo:[1,0,0]
    v_pk_fma_f32 v[206:207], v[118:119], v[28:29], v[206:207] op_sel:[1,1,0] op_sel_hi:[1,0,1] neg_lo:[1,0,0]
    v_pk_fma_f32 v[208:209], v[120:121], v[28:29], v[208:209] op_sel:[1,1,0] op_sel_hi:[1,0,1] neg_lo:[1,0,0]
    v_pk_fma_f32 v[210:211], v[122:123], v[28:29], v[210:211] op_sel:[1,1,0] op_sel_hi:[1,0,1] neg_lo:[1,0,0]
    v_pk_fma_f32 v[68:69], v[36:37], v[204:205], v[68:69] op_sel:[0,0,0] op_sel_hi:[1,0,1]
    v_pk_fma_f32 v[70:71], v[38:39], v[204:205], v[70:71] op_sel:[0,0,0] op_sel_hi:[1,0,1]
    v_pk_fma_f32 v[72:73], v[36:37], v[206:207], v[72:73] op_sel:[0,0,0] op_sel_hi:[1,0,1]
    v_pk_fma_f32 v[74:75], v[38:39], v[206:207], v[74:75] op_sel:[0,0,0] op_sel_hi:[1,0,1]
    v_pk_fma_f32 v[76:77], v[36:37], v[208:209], v[76:77] op_sel:[0,0,0] op_sel_hi:[1,0,1]
    v_pk_fma_f32 v[78:79], v[38:39], v[208:209], v[78:79] op_sel:[0,0,0] op_sel_hi:[1,0,1]
    v_pk_fma_f32 v[80:81], v[36:37], v[210:211], v[80:81] op_sel:[0,0,0] op_sel_hi:[1,0,1]
    v_pk_fma_f32 v[82:83], v[38:39], v[210:211], v[82:83] op_sel:[0,0,0] op_sel_hi:[1,0,1]
    v_pk_fma_f32 v[68:69], v[40:41], v[204:205], v[68:69] op_sel:[0,1,0] op_sel_hi:[1,1,1] neg_lo:[1,0,0] neg_hi:[1,0,0]
    v_pk_fma_f32 v[70:71], v[42:43], v[204:205], v[70:71] op_sel:[0,1,0] op_sel_hi:[1,1,1] neg_lo:[1,0,0] neg_hi:[1,0,0]
    v_pk_fma_f32 v[72:73], v[40:41], v[206:207], v[72:73] op_sel:[0,1,0] op_sel_hi:[1,1,1] neg_lo:[1,0,0] neg_hi:[1,0,0]
    v_pk_fma_f32 v[74:75], v[42:43], v[206:207], v[74:75] op_sel:[0,1,0] op_sel_hi:[1,1,1] neg_lo:[1,0,0] neg_hi:[1,0,0]
    v_pk_fma_f32 v[76:77], v[40:41], v[208:209], v[76:77] op_sel:[0,1,0] op_sel_hi:[1,1,1] neg_lo:[1,0,0] neg_hi:[1,0,0]
    v_pk_fma_f32 v[78:79], v[42:43], v[208:209], v[78:79] op_sel:[0,1,0] op_sel_hi:[1,1,1] neg_lo:[1,0,0] neg_hi:[1,0,0]
    v_pk_fma_f32 v[80:81], v[40:41], v[210:211], v[80:81] op_sel:[0,1,0] op_sel_hi:[1,1,1] neg_lo:[1,0,0] neg_hi:[1,0,0]
    v_pk_fma_f32 v[82:83], v[42:43], v[210:211], v[82:83] op_sel:[0,1,0] op_sel_hi:[1,1,1] neg_lo:[1,0,0] neg_hi:[1,0,0]
    v_cvt_pk_bf16_f32 v84, v68, v69
    v_cvt_pk_bf16_f32 v85, v70, v71
    v_cvt_pk_bf16_f32 v86, v72, v73
    v_cvt_pk_bf16_f32 v87, v74, v75
    v_cvt_pk_bf16_f32 v88, v76, v77
    v_cvt_pk_bf16_f32 v89, v78, v79
    v_cvt_pk_bf16_f32 v90, v80, v81
    v_cvt_pk_bf16_f32 v91, v82, v83
    v_permlane32_swap_b32 v84, v86
    v_permlane32_swap_b32 v85, v87
    v_permlane32_swap_b32 v88, v90
    v_permlane32_swap_b32 v89, v91
    s_nop 0
    v_permlane16_swap_b32 v84, v88
    v_permlane16_swap_b32 v85, v89
    v_permlane16_swap_b32 v86, v90
    v_permlane16_swap_b32 v87, v91
    buffer_store_dwordx4 v[84:87], v176, s[16:19], 0 offen sc1
    buffer_store_dwordx4 v[88:91], v176, s[16:19], 0 offen offset:1024 sc1
    ds_write_b128 v177, v[84:87] offset:16384
    ds_write_b128 v177, v[88:91] offset:17408
    v_pk_fma_f32 v[52:53], v[36:37], v[204:205], v[52:53] op_sel:[0,1,0] op_sel_hi:[1,1,1]
    v_pk_fma_f32 v[54:55], v[38:39], v[204:205], v[54:55] op_sel:[0,1,0] op_sel_hi:[1,1,1]
    v_pk_fma_f32 v[56:57], v[36:37], v[206:207], v[56:57] op_sel:[0,1,0] op_sel_hi:[1,1,1]
    v_pk_fma_f32 v[58:59], v[38:39], v[206:207], v[58:59] op_sel:[0,1,0] op_sel_hi:[1,1,1]
    v_pk_fma_f32 v[60:61], v[36:37], v[208:209], v[60:61] op_sel:[0,1,0] op_sel_hi:[1,1,1]
    v_pk_fma_f32 v[62:63], v[38:39], v[208:209], v[62:63] op_sel:[0,1,0] op_sel_hi:[1,1,1]
    v_pk_fma_f32 v[64:65], v[36:37], v[210:211], v[64:65] op_sel:[0,1,0] op_sel_hi:[1,1,1]
    v_pk_fma_f32 v[66:67], v[38:39], v[210:211], v[66:67] op_sel:[0,1,0] op_sel_hi:[1,1,1]
    v_pk_fma_f32 v[52:53], v[40:41], v[204:205], v[52:53] op_sel:[0,0,0] op_sel_hi:[1,0,1]
    v_pk_fma_f32 v[54:55], v[42:43], v[204:205], v[54:55] op_sel:[0,0,0] op_sel_hi:[1,0,1]
    v_pk_fma_f32 v[56:57], v[40:41], v[206:207], v[56:57] op_sel:[0,0,0] op_sel_hi:[1,0,1]
    v_pk_fma_f32 v[58:59], v[42:43], v[206:207], v[58:59] op_sel:[0,0,0] op_sel_hi:[1,0,1]
    v_pk_fma_f32 v[60:61], v[40:41], v[208:209], v[60:61] op_sel:[0,0,0] op_sel_hi:[1,0,1]
    v_pk_fma_f32 v[62:63], v[42:43], v[208:209], v[62:63] op_sel:[0,0,0] op_sel_hi:[1,0,1]
    v_pk_fma_f32 v[64:65], v[40:41], v[210:211], v[64:65] op_sel:[0,0,0] op_sel_hi:[1,0,1]
    v_pk_fma_f32 v[66:67], v[42:43], v[210:211], v[66:67] op_sel:[0,0,0] op_sel_hi:[1,0,1]
    v_cvt_pk_bf16_f32 v92, -v52, -v53
    v_cvt_pk_bf16_f32 v93, -v54, -v55
    v_cvt_pk_bf16_f32 v94, -v56, -v57
    v_cvt_pk_bf16_f32 v95, -v58, -v59
    v_cvt_pk_bf16_f32 v96, -v60, -v61
    v_cvt_pk_bf16_f32 v97, -v62, -v63
    v_cvt_pk_bf16_f32 v98, -v64, -v65
    v_cvt_pk_bf16_f32 v99, -v66, -v67
    v_permlane32_swap_b32 v92, v94
    v_permlane32_swap_b32 v93, v95
    v_permlane32_swap_b32 v96, v98
    v_permlane32_swap_b32 v97, v99
    s_nop 0
    v_permlane16_swap_b32 v92, v96
    v_permlane16_swap_b32 v93, v97
    v_permlane16_swap_b32 v94, v98
    v_permlane16_swap_b32 v95, v99
    buffer_store_dwordx4 v[92:95], v176, s[16:19], s78 offen sc1
    buffer_store_dwordx4 v[96:99], v176, s[16:19], s78 offen offset:1024 sc1
    ds_write_b128 v177, v[92:95] offset:32768
    ds_write_b128 v177, v[96:99] offset:33792
    s_lshl_b32 s74, s67, 18
    s_add_u32 s74, s74, s77
    v_lshl_add_u32 v226, v1, 4, s74
    v_lshrrev_b32 v214, 2, v222
    v_lshl_add_u32 v215, v3, 3, v214
    v_lshlrev_b32 v215, 6, v215
    v_and_b32 v216, 1, v223
    v_lshl_add_u32 v215, v216, 5, v215
    v_and_b32 v216, 3, v222
    v_lshl_add_u32 v215, v216, 3, v215
    s_lshl_b32 s73, s70, 12
    v_add_u32 v241, s73, v215
    v_add_u32 v242, 0x10000, v241
    s_lshl_b32 s73, s71, 12
    s_add_u32 s73, s73, 0x18000
    v_xor_b32 v216, 0, v253
    v_add_u32 v229, s73, v216
    v_xor_b32 v216, 32, v253
    v_add_u32 v230, s73, v216
    v_xor_b32 v216, 64, v253
    v_add_u32 v231, s73, v216
    v_xor_b32 v216, 96, v253
    v_add_u32 v232, s73, v216
    s_lshl_b32 s72, s67, 19
    s_lshl_b32 s73, s70, 17
    s_add_u32 s72, s72, s73
    s_lshl_b32 s73, s68, 8
    s_add_u32 s72, s72, s73
    s_lshl_b32 s73, s71, 7
    s_add_u32 s72, s72, s73
    v_lshlrev_b32 v214, 14, v3
    v_lshl_add_u32 v214, v2, 2, v214
    v_add_u32 v228, s72, v214
    v_subrev_u32 v233, 0x10000, v229
    v_subrev_u32 v237, 0x18000, v229
    v_subrev_u32 v234, 0x10000, v230
    v_subrev_u32 v238, 0x18000, v230
    v_subrev_u32 v235, 0x10000, v231
    v_subrev_u32 v239, 0x18000, v231
    v_subrev_u32 v236, 0x10000, v232
    v_subrev_u32 v240, 0x18000, v232
    ds_read_b128 v[52:55], v233 offset:16384
    ds_read_b128 v[56:59], v234 offset:16384
    ds_read_b128 v[60:63], v235 offset:16384
    ds_read_b128 v[64:67], v236 offset:16384
    ds_read_b128 v[68:71], v233 offset:24576
    ds_read_b128 v[72:75], v234 offset:24576
    ds_read_b128 v[76:79], v235 offset:24576
    ds_read_b128 v[80:83], v236 offset:24576
    ds_read_b128 v[84:87], v233 offset:32768
    ds_read_b128 v[88:91], v234 offset:32768
    ds_read_b128 v[92:95], v235 offset:32768
    ds_read_b128 v[96:99], v236 offset:32768
    ds_read_b128 v[108:111], v235 offset:40960
    ds_read_b128 v[112:115], v236 offset:40960
    ds_read_b128 v[116:119], v233 offset:49152
    ds_read_b128 v[120:123], v234 offset:49152
    ds_read_b128 v[132:135], v233 offset:57344
    ds_read_b128 v[136:139], v234 offset:57344
    ds_read_b128 v[140:143], v235 offset:57344
    ds_read_b128 v[144:147], v236 offset:57344
    ds_read_b128 v[184:187], v237 offset:8192
    ds_read_b128 v[188:191], v238 offset:8192
    ds_read_b128 v[192:195], v239 offset:8192
    ds_read_b128 v[196:199], v240 offset:8192
    s_waitcnt vmcnt(4)
    ds_read_b128 v[100:103], v233 offset:40960
    ds_read_b128 v[104:107], v234 offset:40960
    ds_read_b128 v[124:127], v235 offset:49152
    ds_read_b128 v[128:131], v236 offset:49152
    s_lshl_b32 s72, s67, 10
    s_add_u32 s79, s72, 0x900000
    s_lshl_b32 s73, s68, 7
    s_add_u32 s3, s73, s79
    v_and_b32 v180, 7, v1
    v_lshlrev_b32 v180, 7, v180
    s_mov_b32 s75, 200000
    s_waitcnt vmcnt(2) lgkmcnt(0)
    s_barrier
    s_cmp_eq_u32 s66, 1
    s_cbranch_scc1 KA_W1
    s_cmp_eq_u32 s66, 0
    s_cbranch_scc1 KA_W0
    s_lshr_b32 s73, s66, 1
    s_cmp_lg_u32 s73, 2
    s_cbranch_scc1 KA_PF0
    s_lshl_b32 s74, s67, 18
    s_lshl_b32 s73, s68, 14
    s_add_u32 s74, s74, s73
    s_and_b32 s73, s66, 1
    s_lshl_b32 s73, s73, 13
    s_add_u32 s74, s74, s73
    v_lshlrev_b32 v215, 7, v1
    buffer_load_dword v200, v215, s[16:19], s74 offen
KA_PF0:
    s_nop 1
    s_waitcnt vmcnt(1)
    s_cmp_lt_u32 s66, 6
    s_cselect_b32 s72, s66, 0
    s_cmp_ge_u32 s72, 4
    s_cbranch_scc1 KA_FOK
    s_waitcnt vmcnt(0)
    s_branch KA_FOK
KA_W0:
    s_nop 1
    buffer_store_dwordx2 v[220:221], v254, s[16:19], s3 offen offset:0
    s_add_u32 s72, s3, 0x10000
    buffer_store_dwordx2 v[220:221], v254, s[16:19], s72 offen offset:0 sc1
    s_waitcnt vmcnt(2)
    s_branch KA_FOK
KA_W1:
    s_nop 1
    buffer_load_dwordx2 v[200:201], v180, s[16:19], s79 offen sc1
    s_sleep 3
    buffer_load_dwordx2 v[202:203], v180, s[16:19], s79 offen sc1
    s_sleep 3
    buffer_load_dwordx2 v[204:205], v180, s[16:19], s79 offen sc1
KA_FP:
    s_waitcnt vmcnt(2)
    v_xor_b32 v182, v200, v220
    v_xor_b32 v183, v201, v221
    v_or_b32 v182, v182, v183
    v_cmp_ne_u32 vcc, 0, v182
    s_nop 2
    s_cbranch_vccz KA_FOK
    buffer_load_dwordx2 v[200:201], v180, s[16:19], s79 offen sc1
    s_waitcnt vmcnt(2)
    v_xor_b32 v182, v202, v220
    v_xor_b32 v183, v203, v221
    v_or_b32 v182, v182, v183
    v_cmp_ne_u32 vcc, 0, v182
    s_nop 2
    s_cbranch_vccz KA_FOK
    buffer_load_dwordx2 v[202:203], v180, s[16:19], s79 offen sc1
    s_waitcnt vmcnt(2)
    v_xor_b32 v182, v204, v220
    v_xor_b32 v183, v205, v221
    v_or_b32 v182, v182, v183
    v_cmp_ne_u32 vcc, 0, v182
    s_nop 2
    s_cbranch_vccz KA_FOK
    buffer_load_dwordx2 v[204:205], v180, s[16:19], s79 offen sc1
    s_cmp_lg_u32 s75, 199992
    s_cbranch_scc1 KA_FNS
    s_or_b32 s79, s79, 0x10000
KA_FNS:
    s_sub_u32 s75, s75, 1
    s_cmp_lg_u32 s75, 0
    s_cbranch_scc1 KA_FP
KA_FOK:
    s_nop 3
    s_barrier
    s_add_u32 m0, s77, 0xc000
    s_mul_i32 s78, s43, 0x4000
    buffer_load_dwordx4 v226, s[16:19], s78 offen sc1 lds
    s_add_u32 m0, s77, 0xc400
    s_mul_i32 s78, s43, 0x4000
    s_add_u32 s78, s78, 0x400
    buffer_load_dwordx4 v226, s[16:19], s78 offen sc1 lds
    s_add_u32 m0, s77, 0x10000
    s_mul_i32 s78, s44, 0x4000
    buffer_load_dwordx4 v226, s[16:19], s78 offen sc1 lds
    s_add_u32 m0, s77, 0x10400
    s_mul_i32 s78, s44, 0x4000
    s_add_u32 s78, s78, 0x400
    buffer_load_dwordx4 v226, s[16:19], s78 offen sc1 lds
    s_add_u32 m0, s77, 0x14000
    s_mul_i32 s78, s45, 0x4000
    buffer_load_dwordx4 v226, s[16:19], s78 offen sc1 lds
    s_add_u32 m0, s77, 0x14400
    s_mul_i32 s78, s45, 0x4000
    s_add_u32 s78, s78, 0x400
    buffer_load_dwordx4 v226, s[16:19], s78 offen sc1 lds
    s_add_u32 m0, s77, 0x0
    s_mul_i32 s78, s46, 0x4000
    buffer_load_dwordx4 v226, s[16:19], s78 offen sc1 lds
    s_add_u32 m0, s77, 0x400
    s_mul_i32 s78, s46, 0x4000
    s_add_u32 s78, s78, 0x400
    buffer_load_dwordx4 v226, s[16:19], s78 offen sc1 lds
    s_cmp_lg_u32 s66, 0
    s_cbranch_scc1 KA_FI
    buffer_store_dwordx2 v[220:221], v254, s[16:19], s3 offen offset:8
    s_add_u32 s72, s3, 0x10000
    buffer_store_dwordx2 v[220:221], v254, s[16:19], s72 offen offset:8 sc1
KA_FI:
    s_nop 1
    s_lshr_b32 s73, s66, 1
    s_cmp_lg_u32 s73, 3
    s_cbranch_scc1 KA_PF1
    s_lshl_b32 s74, s67, 18
    s_lshl_b32 s73, s68, 14
    s_add_u32 s74, s74, s73
    s_and_b32 s73, s66, 1
    s_lshl_b32 s73, s73, 13
    s_add_u32 s74, s74, s73
    s_add_u32 s74, s74, 0x20000
    v_lshlrev_b32 v215, 7, v1
    buffer_load_dword v200, v215, s[16:19], s74 offen
KA_PF1:
    s_nop 1
    s_barrier
    ds_read_b64_tr_b16 v[4:5], v241 offset:16384
    ds_read_b64_tr_b16 v[6:7], v241 offset:16640
    ds_read_b128 v[8:11], v229 offset:0
    ds_read_b64_tr_b16 v[12:13], v241 offset:17408
    ds_read_b64_tr_b16 v[14:15], v241 offset:17664
    ds_read_b128 v[16:19], v230 offset:0
    ds_read_b64_tr_b16 v[20:21], v241 offset:18432
    ds_read_b64_tr_b16 v[22:23], v241 offset:18688
    ds_read_b128 v[24:27], v231 offset:0
    ds_read_b64_tr_b16 v[28:29], v241 offset:19456
    ds_read_b64_tr_b16 v[30:31], v241 offset:19712
    ds_read_b128 v[32:35], v232 offset:0
    s_waitcnt lgkmcnt(9)
    v_mfma_f32_32x32x16_bf16 v[36:51], v[4:7], v[8:11], 0
    s_barrier
    ds_read_b64_tr_b16 v[4:5], v241 offset:32768
    ds_read_b64_tr_b16 v[6:7], v241 offset:33024
    ds_read_b128 v[8:11], v229 offset:8192
    s_waitcnt lgkmcnt(9)
    v_mfma_f32_32x32x16_bf16 v[36:51], v[12:15], v[16:19], v[36:51]
    ds_read_b64_tr_b16 v[12:13], v241 offset:33792
    ds_read_b64_tr_b16 v[14:15], v241 offset:34048
    ds_read_b128 v[16:19], v230 offset:8192
    s_waitcnt lgkmcnt(9)
    v_mfma_f32_32x32x16_bf16 v[36:51], v[20:23], v[24:27], v[36:51]
    ds_read_b64_tr_b16 v[20:21], v241 offset:34816
    ds_read_b64_tr_b16 v[22:23], v241 offset:35072
    ds_read_b128 v[24:27], v231 offset:8192
    s_waitcnt lgkmcnt(9)
    v_mfma_f32_32x32x16_bf16 v[36:51], v[28:31], v[32:35], v[36:51]
    ds_read_b64_tr_b16 v[28:29], v241 offset:35840
    ds_read_b64_tr_b16 v[30:31], v241 offset:36096
    ds_read_b128 v[32:35], v232 offset:8192
    s_waitcnt lgkmcnt(9)
    v_mfma_f32_32x32x16_bf16 v[36:51], v[4:7], v[8:11], v[36:51]
    s_waitcnt vmcnt(6)
    s_barrier
    ds_read_b64_tr_b16 v[4:5], v241 offset:49152
    ds_read_b64_tr_b16 v[6:7], v241 offset:49408
    ds_read_b128 v[8:11], v229 offset:16384
    s_add_u32 m0, s77, 0x4000
    s_mul_i32 s78, s47, 0x4000
    buffer_load_dwordx4 v226, s[16:19], s78 offen sc1 lds
    s_waitcnt lgkmcnt(9)
    v_mfma_f32_32x32x16_bf16 v[36:51], v[12:15], v[16:19], v[36:51]
    s_add_u32 m0, s77, 0x4400
    s_mul_i32 s78, s47, 0x4000
    s_add_u32 s78, s78, 0x400
    buffer_load_dwordx4 v226, s[16:19], s78 offen sc1 lds
    ds_read_b64_tr_b16 v[12:13], v241 offset:50176
    ds_read_b64_tr_b16 v[14:15], v241 offset:50432
    ds_read_b128 v[16:19], v230 offset:16384
    s_waitcnt lgkmcnt(9)
    v_mfma_f32_32x32x16_bf16 v[36:51], v[20:23], v[24:27], v[36:51]
    ds_read_b64_tr_b16 v[20:21], v241 offset:51200
    ds_read_b64_tr_b16 v[22:23], v241 offset:51456
    ds_read_b128 v[24:27], v231 offset:16384
    s_waitcnt lgkmcnt(9)
    v_mfma_f32_32x32x16_bf16 v[36:51], v[28:31], v[32:35], v[36:51]
    ds_read_b64_tr_b16 v[28:29], v241 offset:52224
    ds_read_b64_tr_b16 v[30:31], v241 offset:52480
    ds_read_b128 v[32:35], v232 offset:16384
    s_waitcnt lgkmcnt(9)
    v_mfma_f32_32x32x16_bf16 v[36:51], v[4:7], v[8:11], v[36:51]
    s_waitcnt vmcnt(6)
    s_barrier
    s_cmp_lg_u32 s66, 1
    s_cbranch_scc1 KA_IP
    buffer_load_dwordx2 v[208:209], v180, s[16:19], s79 offen offset:8 sc1
KA_IP:
    s_nop 1
    ds_read_b64_tr_b16 v[4:5], v242 offset:0
    ds_read_b64_tr_b16 v[6:7], v242 offset:256
    ds_read_b128 v[8:11], v229 offset:24576
    s_add_u32 m0, s77, 0x8000
    s_mul_i32 s78, s48, 0x4000
    buffer_load_dwordx4 v226, s[16:19], s78 offen sc1 lds
    s_waitcnt lgkmcnt(9)
    v_mfma_f32_32x32x16_bf16 v[36:51], v[12:15], v[16:19], v[36:51]
    s_add_u32 m0, s77, 0x8400
    s_mul_i32 s78, s48, 0x4000
    s_add_u32 s78, s78, 0x400
    buffer_load_dwordx4 v226, s[16:19], s78 offen sc1 lds
    ds_read_b64_tr_b16 v[12:13], v242 offset:1024
    ds_read_b64_tr_b16 v[14:15], v242 offset:1280
    ds_read_b128 v[16:19], v230 offset:24576
    s_waitcnt lgkmcnt(9)
    v_mfma_f32_32x32x16_bf16 v[36:51], v[20:23], v[24:27], v[36:51]
    ds_read_b64_tr_b16 v[20:21], v242 offset:2048
    ds_read_b64_tr_b16 v[22:23], v242 offset:2304
    ds_read_b128 v[24:27], v231 offset:24576
    s_waitcnt lgkmcnt(9)
    v_mfma_f32_32x32x16_bf16 v[36:51], v[28:31], v[32:35], v[36:51]
    ds_read_b64_tr_b16 v[28:29], v242 offset:3072
    ds_read_b64_tr_b16 v[30:31], v242 offset:3328
    ds_read_b128 v[32:35], v232 offset:24576
    s_waitcnt lgkmcnt(9)
    v_mfma_f32_32x32x16_bf16 v[36:51], v[4:7], v[8:11], v[36:51]
    s_waitcnt vmcnt(6)
    s_barrier
    ds_read_b64_tr_b16 v[4:5], v242 offset:16384
    ds_read_b64_tr_b16 v[6:7], v242 offset:16640
    ds_read_b128 v[8:11], v229 offset:32768
    s_add_u32 m0, s77, 0xc000
    s_mul_i32 s78, s49, 0x4000
    buffer_load_dwordx4 v226, s[16:19], s78 offen sc1 lds
    s_waitcnt lgkmcnt(9)
    v_mfma_f32_32x32x16_bf16 v[36:51], v[12:15], v[16:19], v[36:51]
    s_add_u32 m0, s77, 0xc400
    s_mul_i32 s78, s49, 0x4000
    s_add_u32 s78, s78, 0x400
    buffer_load_dwordx4 v226, s[16:19], s78 offen sc1 lds
    ds_read_b64_tr_b16 v[12:13], v242 offset:17408
    ds_read_b64_tr_b16 v[14:15], v242 offset:17664
    ds_read_b128 v[16:19], v230 offset:32768
    s_waitcnt lgkmcnt(9)
    v_mfma_f32_32x32x16_bf16 v[36:51], v[20:23], v[24:27], v[36:51]
    ds_read_b64_tr_b16 v[20:21], v242 offset:18432
    ds_read_b64_tr_b16 v[22:23], v242 offset:18688
    ds_read_b128 v[24:27], v231 offset:32768
    s_waitcnt lgkmcnt(9)
    v_mfma_f32_32x32x16_bf16 v[36:51], v[28:31], v[32:35], v[36:51]
    ds_read_b64_tr_b16 v[28:29], v242 offset:19456
    ds_read_b64_tr_b16 v[30:31], v242 offset:19712
    ds_read_b128 v[32:35], v232 offset:32768
    s_waitcnt lgkmcnt(9)
    v_mfma_f32_32x32x16_bf16 v[36:51], v[4:7], v[8:11], v[36:51]
    s_waitcnt vmcnt(6)
    s_cmp_lg_u32 s66, 1
    s_cbranch_scc1 KA_IOK
    s_waitcnt vmcnt(4)
    v_xor_b32 v182, v208, v220
    v_xor_b32 v183, v209, v221
    v_or_b32 v182, v182, v183
    v_cmp_ne_u32 vcc, 0, v182
    s_nop 2
    s_cbranch_vccz KA_IOK
    s_mov_b32 s75, 200000
KA_IL:
    buffer_load_dwordx2 v[208:209], v180, s[16:19], s79 offen offset:8 sc1
    s_waitcnt vmcnt(0)
    v_xor_b32 v182, v208, v220
    v_xor_b32 v183, v209, v221
    v_or_b32 v182, v182, v183
    v_cmp_ne_u32 vcc, 0, v182
    s_nop 2
    s_cbranch_vccz KA_IOK
    s_cmp_lg_u32 s75, 199976
    s_cbranch_scc1 KA_INS
    s_or_b32 s79, s79, 0x10000
KA_INS:
    s_sub_u32 s75, s75, 1
    s_cmp_lg_u32 s75, 0
    s_cbranch_scc1 KA_IL
KA_IOK:
    s_nop 3
    s_barrier
    ds_read_b64_tr_b16 v[4:5], v241 offset:0
    ds_read_b64_tr_b16 v[6:7], v241 offset:256
    ds_read_b128 v[8:11], v229 offset:40960
    s_add_u32 m0, s77, 0x10000
    s_mul_i32 s78, s43, 0x4000
    s_add_u32 s78, s78, 0x20000
    buffer_load_dwordx4 v226, s[16:19], s78 offen sc1 lds
    s_waitcnt lgkmcnt(9)
    v_mfma_f32_32x32x16_bf16 v[36:51], v[12:15], v[16:19], v[36:51]
    s_add_u32 m0, s77, 0x10400
    s_mul_i32 s78, s43, 0x4000
    s_add_u32 s78, s78, 0x20400
    buffer_load_dwordx4 v226, s[16:19], s78 offen sc1 lds
    ds_read_b64_tr_b16 v[12:13], v241 offset:1024
    ds_read_b64_tr_b16 v[14:15], v241 offset:1280
    ds_read_b128 v[16:19], v230 offset:40960
    s_waitcnt lgkmcnt(9)
    v_mfma_f32_32x32x16_bf16 v[36:51], v[20:23], v[24:27], v[36:51]
    ds_read_b64_tr_b16 v[20:21], v241 offset:2048
    ds_read_b64_tr_b16 v[22:23], v241 offset:2304
    ds_read_b128 v[24:27], v231 offset:40960
    s_waitcnt lgkmcnt(9)
    v_mfma_f32_32x32x16_bf16 v[36:51], v[28:31], v[32:35], v[36:51]
    ds_read_b64_tr_b16 v[28:29], v241 offset:3072
    ds_read_b64_tr_b16 v[30:31], v241 offset:3328
    ds_read_b128 v[32:35], v232 offset:40960
    s_waitcnt lgkmcnt(9)
    v_mfma_f32_32x32x16_bf16 v[36:51], v[4:7], v[8:11], v[36:51]
    s_waitcnt vmcnt(6)
    s_barrier
    ds_read_b64_tr_b16 v[4:5], v241 offset:16384
    ds_read_b64_tr_b16 v[6:7], v241 offset:16640
    ds_read_b128 v[8:11], v229 offset:49152
    s_add_u32 m0, s77, 0x14000
    s_mul_i32 s78, s44, 0x4000
    s_add_u32 s78, s78, 0x20000
    buffer_load_dwordx4 v226, s[16:19], s78 offen sc1 lds
    s_waitcnt lgkmcnt(9)
    v_mfma_f32_32x32x16_bf16 v[36:51], v[12:15], v[16:19], v[36:51]
    s_add_u32 m0, s77, 0x14400
    s_mul_i32 s78, s44, 0x4000
    s_add_u32 s78, s78, 0x20400
    buffer_load_dwordx4 v226, s[16:19], s78 offen sc1 lds
    ds_read_b64_tr_b16 v[12:13], v241 offset:17408
    ds_read_b64_tr_b16 v[14:15], v241 offset:17664
    ds_read_b128 v[16:19], v230 offset:49152
    s_waitcnt lgkmcnt(9)
    v_mfma_f32_32x32x16_bf16 v[36:51], v[20:23], v[24:27], v[36:51]
    ds_read_b64_tr_b16 v[20:21], v241 offset:18432
    ds_read_b64_tr_b16 v[22:23], v241 offset:18688
    ds_read_b128 v[24:27], v231 offset:49152
    s_waitcnt lgkmcnt(9)
    v_mfma_f32_32x32x16_bf16 v[36:51], v[28:31], v[32:35], v[36:51]
    ds_read_b64_tr_b16 v[28:29], v241 offset:19456
    ds_read_b64_tr_b16 v[30:31], v241 offset:19712
    ds_read_b128 v[32:35], v232 offset:49152
    s_waitcnt lgkmcnt(9)
    v_mfma_f32_32x32x16_bf16 v[36:51], v[4:7], v[8:11], v[36:51]
    s_waitcnt vmcnt(6)
    s_barrier
    ds_read_b64_tr_b16 v[4:5], v241 offset:32768
    ds_read_b64_tr_b16 v[6:7], v241 offset:33024
    ds_read_b128 v[8:11], v229 offset:57344
    s_add_u32 m0, s77, 0x0
    s_mul_i32 s78, s45, 0x4000
    s_add_u32 s78, s78, 0x20000
    buffer_load_dwordx4 v226, s[16:19], s78 offen sc1 lds
    s_waitcnt lgkmcnt(9)
    v_mfma_f32_32x32x16_bf16 v[36:51], v[12:15], v[16:19], v[36:51]
    s_add_u32 m0, s77, 0x400
    s_mul_i32 s78, s45, 0x4000
    s_add_u32 s78, s78, 0x20400
    buffer_load_dwordx4 v226, s[16:19], s78 offen sc1 lds
    ds_read_b64_tr_b16 v[12:13], v241 offset:33792
    ds_read_b64_tr_b16 v[14:15], v241 offset:34048
    ds_read_b128 v[16:19], v230 offset:57344
    s_waitcnt lgkmcnt(9)
    v_mfma_f32_32x32x16_bf16 v[36:51], v[20:23], v[24:27], v[36:51]
    ds_read_b64_tr_b16 v[20:21], v241 offset:34816
    ds_read_b64_tr_b16 v[22:23], v241 offset:35072
    ds_read_b128 v[24:27], v231 offset:57344
    s_waitcnt lgkmcnt(9)
    v_mfma_f32_32x32x16_bf16 v[36:51], v[28:31], v[32:35], v[36:51]
    ds_read_b64_tr_b16 v[28:29], v241 offset:35840
    ds_read_b64_tr_b16 v[30:31], v241 offset:36096
    ds_read_b128 v[32:35], v232 offset:57344
    s_waitcnt lgkmcnt(9)
    v_mfma_f32_32x32x16_bf16 v[36:51], v[4:7], v[8:11], v[36:51]
    s_waitcnt vmcnt(6)
    s_barrier
    ds_read_b64_tr_b16 v[4:5], v241 offset:49152
    ds_read_b64_tr_b16 v[6:7], v241 offset:49408
    s_add_u32 m0, s77, 0x4000
    s_mul_i32 s78, s46, 0x4000
    s_add_u32 s78, s78, 0x20000
    buffer_load_dwordx4 v226, s[16:19], s78 offen sc1 lds
    s_waitcnt lgkmcnt(8)
    v_mfma_f32_32x32x16_bf16 v[36:51], v[12:15], v[16:19], v[36:51]
    s_add_u32 m0, s77, 0x4400
    s_mul_i32 s78, s46, 0x4000
    s_add_u32 s78, s78, 0x20400
    buffer_load_dwordx4 v226, s[16:19], s78 offen sc1 lds
    ds_read_b64_tr_b16 v[12:13], v241 offset:50176
    ds_read_b64_tr_b16 v[14:15], v241 offset:50432
    s_waitcnt lgkmcnt(7)
    v_mfma_f32_32x32x16_bf16 v[36:51], v[20:23], v[24:27], v[36:51]
    ds_read_b64_tr_b16 v[20:21], v241 offset:51200
    ds_read_b64_tr_b16 v[22:23], v241 offset:51456
    s_waitcnt lgkmcnt(6)
    v_mfma_f32_32x32x16_bf16 v[36:51], v[28:31], v[32:35], v[36:51]
    ds_read_b64_tr_b16 v[28:29], v241 offset:52224
    ds_read_b64_tr_b16 v[30:31], v241 offset:52480
    s_waitcnt lgkmcnt(6)
    v_mfma_f32_32x32x16_bf16 v[36:51], v[4:7], v[52:55], v[36:51]
    s_waitcnt vmcnt(6)
    s_barrier
    ds_read_b64_tr_b16 v[4:5], v242 offset:0
    ds_read_b64_tr_b16 v[6:7], v242 offset:256
    s_add_u32 m0, s76, 0x26000
    s_mul_i32 s78, s49, 0x80
    buffer_load_dwordx4 v225, s[32:35], s78 offen lds
    s_waitcnt lgkmcnt(6)
    v_mfma_f32_32x32x16_bf16 v[36:51], v[12:15], v[56:59], v[36:51]
    s_add_u32 m0, s77, 0x8000
    s_mul_i32 s78, s47, 0x4000
    s_add_u32 s78, s78, 0x20000
    buffer_load_dwordx4 v226, s[16:19], s78 offen sc1 lds
    ds_read_b64_tr_b16 v[12:13], v242 offset:1024
    ds_read_b64_tr_b16 v[14:15], v242 offset:1280
    s_waitcnt lgkmcnt(6)
    v_mfma_f32_32x32x16_bf16 v[36:51], v[20:23], v[60:63], v[36:51]
    s_add_u32 m0, s77, 0x8400
    s_mul_i32 s78, s47, 0x4000
    s_add_u32 s78, s78, 0x20400
    buffer_load_dwordx4 v226, s[16:19], s78 offen sc1 lds
    ds_read_b64_tr_b16 v[20:21], v242 offset:2048
    ds_read_b64_tr_b16 v[22:23], v242 offset:2304
    s_waitcnt lgkmcnt(6)
    v_mfma_f32_32x32x16_bf16 v[36:51], v[28:31], v[64:67], v[36:51]
    ds_read_b64_tr_b16 v[28:29], v242 offset:3072
    ds_read_b64_tr_b16 v[30:31], v242 offset:3328
    s_waitcnt lgkmcnt(6)
    v_mfma_f32_32x32x16_bf16 v[36:51], v[4:7], v[68:71], v[36:51]
    s_waitcnt vmcnt(7)
    s_barrier
    ds_read_b64_tr_b16 v[4:5], v242 offset:16384
    ds_read_b64_tr_b16 v[6:7], v242 offset:16640
    s_add_u32 m0, s77, 0xc000
    s_mul_i32 s78, s48, 0x4000
    s_add_u32 s78, s78, 0x20000
    buffer_load_dwordx4 v226, s[16:19], s78 offen sc1 lds
    s_waitcnt lgkmcnt(6)
    v_mfma_f32_32x32x16_bf16 v[36:51], v[12:15], v[72:75], v[36:51]
    s_add_u32 m0, s77, 0xc400
    s_mul_i32 s78, s48, 0x4000
    s_add_u32 s78, s78, 0x20400
    buffer_load_dwordx4 v226, s[16:19], s78 offen sc1 lds
    ds_read_b64_tr_b16 v[12:13], v242 offset:17408
    ds_read_b64_tr_b16 v[14:15], v242 offset:17664
    s_waitcnt lgkmcnt(6)
    v_mfma_f32_32x32x16_bf16 v[36:51], v[20:23], v[76:79], v[36:51]
    ds_read_b64_tr_b16 v[20:21], v242 offset:18432
    ds_read_b64_tr_b16 v[22:23], v242 offset:18688
    s_waitcnt lgkmcnt(6)
    v_mfma_f32_32x32x16_bf16 v[36:51], v[28:31], v[80:83], v[36:51]
    ds_read_b64_tr_b16 v[28:29], v242 offset:19456
    ds_read_b64_tr_b16 v[30:31], v242 offset:19712
    s_waitcnt lgkmcnt(6)
    v_mfma_f32_32x32x16_bf16 v[36:51], v[4:7], v[84:87], v[36:51]
    s_waitcnt vmcnt(7)
    s_barrier
    ds_read_b64_tr_b16 v[4:5], v241 offset:0
    ds_read_b64_tr_b16 v[6:7], v241 offset:256
    s_add_u32 m0, s77, 0x10000
    s_mul_i32 s78, s49, 0x4000
    s_add_u32 s78, s78, 0x20000
    buffer_load_dwordx4 v226, s[16:19], s78 offen sc1 lds
    s_waitcnt lgkmcnt(6)
    v_mfma_f32_32x32x16_bf16 v[36:51], v[12:15], v[88:91], v[36:51]
    s_add_u32 m0, s77, 0x10400
    s_mul_i32 s78, s49, 0x4000
    s_add_u32 s78, s78, 0x20400
    buffer_load_dwordx4 v226, s[16:19], s78 offen sc1 lds
    ds_read_b64_tr_b16 v[12:13], v241 offset:1024
    ds_read_b64_tr_b16 v[14:15], v241 offset:1280
    s_waitcnt lgkmcnt(6)
    v_mfma_f32_32x32x16_bf16 v[36:51], v[20:23], v[92:95], v[36:51]
    ds_read_b64_tr_b16 v[20:21], v241 offset:2048
    ds_read_b64_tr_b16 v[22:23], v241 offset:2304
    s_waitcnt lgkmcnt(6)
    v_mfma_f32_32x32x16_bf16 v[36:51], v[28:31], v[96:99], v[36:51]
    ds_read_b64_tr_b16 v[28:29], v241 offset:3072
    ds_read_b64_tr_b16 v[30:31], v241 offset:3328
    s_waitcnt lgkmcnt(6)
    v_mfma_f32_32x32x16_bf16 v[36:51], v[4:7], v[100:103], v[36:51]
    s_waitcnt vmcnt(7)
    s_barrier
    ds_read_b64_tr_b16 v[4:5], v241 offset:16384
    ds_read_b64_tr_b16 v[6:7], v241 offset:16640
    s_waitcnt lgkmcnt(6)
    v_mfma_f32_32x32x16_bf16 v[36:51], v[12:15], v[104:107], v[36:51]
    ds_read_b64_tr_b16 v[12:13], v241 offset:17408
    ds_read_b64_tr_b16 v[14:15], v241 offset:17664
    s_waitcnt lgkmcnt(6)
    v_mfma_f32_32x32x16_bf16 v[36:51], v[20:23], v[108:111], v[36:51]
    ds_read_b64_tr_b16 v[20:21], v241 offset:18432
    ds_read_b64_tr_b16 v[22:23], v241 offset:18688
    s_waitcnt lgkmcnt(6)
    v_mfma_f32_32x32x16_bf16 v[36:51], v[28:31], v[112:115], v[36:51]
    ds_read_b64_tr_b16 v[28:29], v241 offset:19456
    ds_read_b64_tr_b16 v[30:31], v241 offset:19712
    s_waitcnt lgkmcnt(6)
    v_mfma_f32_32x32x16_bf16 v[36:51], v[4:7], v[116:119], v[36:51]
    s_waitcnt vmcnt(4)
    s_barrier
    ds_read_b64_tr_b16 v[4:5], v241 offset:32768
    ds_read_b64_tr_b16 v[6:7], v241 offset:33024
    s_waitcnt lgkmcnt(6)
    v_mfma_f32_32x32x16_bf16 v[36:51], v[12:15], v[120:123], v[36:51]
    ds_read_b64_tr_b16 v[12:13], v241 offset:33792
    ds_read_b64_tr_b16 v[14:15], v241 offset:34048
    s_waitcnt lgkmcnt(6)
    v_mfma_f32_32x32x16_bf16 v[36:51], v[20:23], v[124:127], v[36:51]
    ds_read_b64_tr_b16 v[20:21], v241 offset:34816
    ds_read_b64_tr_b16 v[22:23], v241 offset:35072
    s_waitcnt lgkmcnt(6)
    v_mfma_f32_32x32x16_bf16 v[36:51], v[28:31], v[128:131], v[36:51]
    ds_read_b64_tr_b16 v[28:29], v241 offset:35840
    ds_read_b64_tr_b16 v[30:31], v241 offset:36096
    s_waitcnt lgkmcnt(6)
    v_mfma_f32_32x32x16_bf16 v[36:51], v[4:7], v[132:135], v[36:51]
    s_waitcnt vmcnt(2)
    s_barrier
    ds_read_b64_tr_b16 v[4:5], v241 offset:49152
    ds_read_b64_tr_b16 v[6:7], v241 offset:49408
    s_waitcnt lgkmcnt(6)
    v_mfma_f32_32x32x16_bf16 v[36:51], v[12:15], v[136:139], v[36:51]
    ds_read_b64_tr_b16 v[12:13], v241 offset:50176
    ds_read_b64_tr_b16 v[14:15], v241 offset:50432
    s_waitcnt lgkmcnt(6)
    v_mfma_f32_32x32x16_bf16 v[36:51], v[20:23], v[140:143], v[36:51]
    ds_read_b64_tr_b16 v[20:21], v241 offset:51200
    ds_read_b64_tr_b16 v[22:23], v241 offset:51456
    s_waitcnt lgkmcnt(6)
    v_mfma_f32_32x32x16_bf16 v[36:51], v[28:31], v[144:147], v[36:51]
    ds_read_b64_tr_b16 v[28:29], v241 offset:52224
    ds_read_b64_tr_b16 v[30:31], v241 offset:52480
    s_waitcnt lgkmcnt(6)
    v_mfma_f32_32x32x16_bf16 v[36:51], v[4:7], v[184:187], v[36:51]
    s_waitcnt vmcnt(0)
    s_barrier
    ds_read_b64_tr_b16 v[4:5], v242 offset:0
    ds_read_b64_tr_b16 v[6:7], v242 offset:256
    ds_read_b128 v[8:11], v229 offset:57344
    s_waitcnt lgkmcnt(7)
    v_mfma_f32_32x32x16_bf16 v[36:51], v[12:15], v[188:191], v[36:51]
    ds_read_b64_tr_b16 v[12:13], v242 offset:1024
    ds_read_b64_tr_b16 v[14:15], v242 offset:1280
    ds_read_b128 v[16:19], v230 offset:57344
    s_waitcnt lgkmcnt(8)
    v_mfma_f32_32x32x16_bf16 v[36:51], v[20:23], v[192:195], v[36:51]
    ds_read_b64_tr_b16 v[20:21], v242 offset:2048
    ds_read_b64_tr_b16 v[22:23], v242 offset:2304
    ds_read_b128 v[24:27], v231 offset:57344
    s_waitcnt lgkmcnt(9)
    v_mfma_f32_32x32x16_bf16 v[36:51], v[28:31], v[196:199], v[36:51]
    ds_read_b64_tr_b16 v[28:29], v242 offset:3072
    ds_read_b64_tr_b16 v[30:31], v242 offset:3328
    ds_read_b128 v[32:35], v232 offset:57344
    s_waitcnt lgkmcnt(9)
    v_mfma_f32_32x32x16_bf16 v[36:51], v[4:7], v[8:11], v[36:51]
    s_waitcnt lgkmcnt(6)
    v_mfma_f32_32x32x16_bf16 v[36:51], v[12:15], v[16:19], v[36:51]
    s_waitcnt lgkmcnt(3)
    v_mfma_f32_32x32x16_bf16 v[36:51], v[20:23], v[24:27], v[36:51]
    s_waitcnt lgkmcnt(0)
    v_mfma_f32_32x32x16_bf16 v[36:51], v[28:31], v[32:35], v[36:51]
    s_nop 11
    v_fma_f32 v148, 2.0, v36, v148
    s_mov_b32 s78, 0x0
    buffer_store_dword v148, v228, s[24:27], s78 offen sc1
    v_fma_f32 v149, 2.0, v37, v149
    s_mov_b32 s78, 0x1000
    buffer_store_dword v149, v228, s[24:27], s78 offen sc1
    v_fma_f32 v150, 2.0, v38, v150
    s_mov_b32 s78, 0x2000
    buffer_store_dword v150, v228, s[24:27], s78 offen sc1
    v_fma_f32 v151, 2.0, v39, v151
    s_mov_b32 s78, 0x3000
    buffer_store_dword v151, v228, s[24:27], s78 offen sc1
    v_fma_f32 v152, 2.0, v40, v152
    s_mov_b32 s78, 0x8000
    buffer_store_dword v152, v228, s[24:27], s78 offen sc1
    v_fma_f32 v153, 2.0, v41, v153
    s_mov_b32 s78, 0x9000
    buffer_store_dword v153, v228, s[24:27], s78 offen sc1
    v_fma_f32 v154, 2.0, v42, v154
    s_mov_b32 s78, 0xa000
    buffer_store_dword v154, v228, s[24:27], s78 offen sc1
    v_fma_f32 v155, 2.0, v43, v155
    s_mov_b32 s78, 0xb000
    buffer_store_dword v155, v228, s[24:27], s78 offen sc1
    v_fma_f32 v156, 2.0, v44, v156
    s_mov_b32 s78, 0x10000
    buffer_store_dword v156, v228, s[24:27], s78 offen sc1
    v_fma_f32 v157, 2.0, v45, v157
    s_mov_b32 s78, 0x11000
    buffer_store_dword v157, v228, s[24:27], s78 offen sc1
    v_fma_f32 v158, 2.0, v46, v158
    s_mov_b32 s78, 0x12000
    buffer_store_dword v158, v228, s[24:27], s78 offen sc1
    v_fma_f32 v159, 2.0, v47, v159
    s_mov_b32 s78, 0x13000
    buffer_store_dword v159, v228, s[24:27], s78 offen sc1
    v_fma_f32 v160, 2.0, v48, v160
    s_mov_b32 s78, 0x18000
    buffer_store_dword v160, v228, s[24:27], s78 offen sc1
    v_fma_f32 v161, 2.0, v49, v161
    s_mov_b32 s78, 0x19000
    buffer_store_dword v161, v228, s[24:27], s78 offen sc1
    v_fma_f32 v162, 2.0, v50, v162
    s_mov_b32 s78, 0x1a000
    buffer_store_dword v162, v228, s[24:27], s78 offen sc1
    v_fma_f32 v163, 2.0, v51, v163
    s_mov_b32 s78, 0x1b000
    buffer_store_dword v163, v228, s[24:27], s78 offen sc1
    s_branch K_END
KA_ENC0:
    s_waitcnt vmcnt(0)
    s_barrier
    s_branch KA_ENC
KB_P2_S:
    buffer_load_dword v219, v254, s[28:31], 0 offen sc1
    s_branch KB_P2_D
K_B:
    s_nop 3
    s_lshl_b32 s74, s68, 7
    s_add_u32 s74, s74, 1024
    s_xor_b32 s75, s68, 0
    s_sub_u32 s75, s75, s68
    s_lshl_b32 s75, s75, 7
    s_add_u32 s75, s75, 64
    s_lshl_b32 s73, s66, 3
    v_add_u32 v215, s73, v223
    v_lshrrev_b32 v216, 2, v222
    v_xor_b32 v216, v216, v223
    v_mul_u32_u24 v215, 0xc00, v215
    v_lshrrev_b32 v217, 1, v216
    v_lshl_add_u32 v215, v217, 10, v215
    v_and_b32 v216, 1, v216
    v_mul_lo_u32 v216, v216, s75
    v_add_u32 v215, v216, v215
    v_and_b32 v216, 3, v222
    v_lshl_add_u32 v215, v216, 4, v215
    v_add_u32 v226, s74, v215
    s_lshl_b32 s73, s66, 3
    v_add_u32 v215, s73, v223
    v_add_u32 v215, 4, v215
    v_lshrrev_b32 v216, 2, v222
    v_xor_b32 v216, v216, v223
    v_mul_u32_u24 v215, 0xc00, v215
    v_lshrrev_b32 v217, 1, v216
    v_lshl_add_u32 v215, v217, 10, v215
    v_and_b32 v216, 1, v216
    v_mul_lo_u32 v216, v216, s75
    v_add_u32 v215, v216, v215
    v_and_b32 v216, 3, v222
    v_lshl_add_u32 v215, v216, 4, v215
    v_add_u32 v227, s74, v215
    s_mov_b32 s6, 0x200000
    s_mov_b32 s7, 0x00020000
    s_mov_b32 s10, 0x180000
    s_mov_b32 s11, 0x00020000
    s_and_b32 s73, s68, 6
    s_add_u32 s72, s67, s73
    s_and_b32 s72, s72, 7
    s_lshl_b32 s3, s72, 7
    s_add_u32 s78, s3, 0x10000
    s_mul_i32 s79, s72, 0x30000
    s_lshl_b32 s72, s70, 12
    v_xor_b32 v216, 0, v253
    v_add_u32 v229, s72, v216
    v_add_u32 v233, 0x10000, v229
    v_add_u32 v237, 0x20000, v229
    v_xor_b32 v216, 32, v253
    v_add_u32 v230, s72, v216
    v_add_u32 v234, 0x10000, v230
    v_add_u32 v238, 0x20000, v230
    v_xor_b32 v216, 64, v253
    v_add_u32 v231, s72, v216
    v_add_u32 v235, 0x10000, v231
    v_add_u32 v239, 0x20000, v231
    v_xor_b32 v216, 96, v253
    v_add_u32 v232, s72, v216
    v_add_u32 v236, 0x10000, v232
    v_add_u32 v240, 0x20000, v232
    s_mov_b32 m0, s76
    s_waitcnt lgkmcnt(0)
    s_mov_b64 s[4:5], s[54:55]
    s_mov_b64 s[8:9], s[56:57]
    buffer_load_dwordx4 v224, s[4:7], s3 offen lds
    s_add_u32 m0, s76, 0x2000
    s_nop 0
    buffer_load_dwordx4 v224, s[4:7], s78 offen lds
    s_add_u32 m0, s77, 0x4000
    s_nop 0
    buffer_load_dwordx4 v226, s[8:11], s79 offen lds
    s_add_u32 m0, s77, 0x4400
    s_nop 0
    buffer_load_dwordx4 v227, s[8:11], s79 offen lds
    s_mov_b32 s16, s64
    s_and_b32 s17, s65, 0xffff
    s_mov_b32 s18, 0x10000000
    s_mov_b32 s19, 0x00020000
    s_mov_b32 s20, s62
    s_and_b32 s21, s63, 0xffff
    s_mov_b32 s22, 0x100
    s_mov_b32 s23, 0x00020000
    s_mov_b32 s24, s60
    s_and_b32 s25, s61, 0xffff
    s_mov_b32 s26, 0x800000
    s_mov_b32 s27, 0x00020000
    s_mov_b32 s28, s58
    s_and_b32 s29, s59, 0xffff
    s_mov_b32 s30, 0x80000
    s_mov_b32 s31, 0x00020000
    s_lshl_b32 s72, s67, 1
    s_and_b32 s73, s68, 6
    s_add_u32 s72, s67, s73
    s_add_u32 s58, s72, 0
    s_and_b32 s58, s58, 7
    s_add_u32 s59, s72, 1
    s_and_b32 s59, s59, 7
    s_add_u32 s60, s72, 2
    s_and_b32 s60, s60, 7
    s_add_u32 s61, s72, 3
    s_and_b32 s61, s61, 7
    s_add_u32 s62, s72, 4
    s_and_b32 s62, s62, 7
    s_add_u32 s63, s72, 5
    s_and_b32 s63, s63, 7
    s_add_u32 s64, s72, 6
    s_and_b32 s64, s64, 7
    s_add_u32 s65, s72, 7
    s_and_b32 s65, s65, 7
    s_add_u32 s42, s68, 0
    s_and_b32 s42, s42, 7
    s_add_u32 s43, s68, 1
    s_and_b32 s43, s43, 7
    s_add_u32 s44, s68, 2
    s_and_b32 s44, s44, 7
    s_add_u32 s45, s68, 3
    s_and_b32 s45, s45, 7
    s_add_u32 s46, s68, 4
    s_and_b32 s46, s46, 7
    s_add_u32 s47, s68, 5
    s_and_b32 s47, s47, 7
    s_add_u32 s48, s68, 6
    s_and_b32 s48, s48, 7
    s_add_u32 s49, s68, 7
    s_and_b32 s49, s49, 7
    s_barrier
    s_add_u32 m0, s76, 0x8000
    s_mul_i32 s78, s59, 0x80
    buffer_load_dwordx4 v224, s[4:7], s78 offen lds
    s_add_u32 m0, s76, 0xa000
    s_mul_i32 s78, s59, 0x80
    s_add_u32 s78, s78, 0x10000
    buffer_load_dwordx4 v224, s[4:7], s78 offen lds
    s_add_u32 m0, s77, 0xc000
    s_mul_i32 s78, s59, 0x30000
    buffer_load_dwordx4 v226, s[8:11], s78 offen lds
    s_add_u32 m0, s77, 0xc400
    s_mul_i32 s78, s59, 0x30000
    buffer_load_dwordx4 v227, s[8:11], s78 offen lds
    s_lshl_b32 s72, s67, 1
    s_sub_u32 s73, s68, s72
    s_and_b32 s73, s73, 7
    s_cmp_le_u32 s73, 0
    s_addc_u32 s43, s72, 0
    s_and_b32 s43, s43, 7
    s_cmp_le_u32 s73, 1
    s_addc_u32 s44, s72, 1
    s_and_b32 s44, s44, 7
    s_cmp_le_u32 s73, 2
    s_addc_u32 s45, s72, 2
    s_and_b32 s45, s45, 7
    s_cmp_le_u32 s73, 3
    s_addc_u32 s46, s72, 3
    s_and_b32 s46, s46, 7
    s_cmp_le_u32 s73, 4
    s_addc_u32 s47, s72, 4
    s_and_b32 s47, s47, 7
    s_cmp_le_u32 s73, 5
    s_addc_u32 s48, s72, 5
    s_and_b32 s48, s48, 7
    s_cmp_le_u32 s73, 6
    s_addc_u32 s49, s72, 6
    s_and_b32 s49, s49, 7
    s_mul_i32 s72, s71, 0
    s_xor_b32 s50, s42, s72
    s_xor_b32 s51, s43, s72
    s_xor_b32 s52, s44, s72
    s_xor_b32 s53, s45, s72
    s_xor_b32 s54, s46, s72
    s_xor_b32 s55, s47, s72
    s_xor_b32 s56, s48, s72
    s_xor_b32 s57, s49, s72
    s_lshl_b32 s73, s66, 3
    v_lshrrev_b32 v215, 3, v1
    v_add_u32 v215, s73, v215
    v_and_b32 v216, 7, v1
    v_bfe_u32 v217, v215, 1, 1
    v_lshlrev_b32 v217, 2, v217
    v_xor_b32 v216, v216, v217
    v_lshlrev_b32 v216, 4, v216
    s_lshl_b32 s74, s68, 7
    v_add_u32 v216, s74, v216
    v_mul_u32_u24 v217, 0xc00, v215
    v_add_u32 v228, v217, v216
    v_lshl_add_u32 v225, v215, 10, v216
    v_bfe_u32 v217, v216, 6, 1
    s_sub_u32 s72, s75, 64
    v_mul_lo_u32 v217, v217, s72
    v_add_u32 v228, v217, v228
    v_lshrrev_b32 v214, 2, v222
    v_lshl_add_u32 v215, v3, 3, v214
    v_lshlrev_b32 v215, 8, v215
    v_xor_b32 v214, s71, v214
    v_lshl_add_u32 v215, v214, 6, v215
    v_and_b32 v216, 1, v223
    v_lshl_add_u32 v215, v216, 5, v215
    v_and_b32 v216, 3, v222
    v_lshl_add_u32 v241, v216, 3, v215
    v_add_u32 v241, 0x4000, v241
    v_xor_b32 v242, 0x80, v241
    v_lshrrev_b32 v214, 2, v222
    v_lshl_add_u32 v215, v3, 3, v214
    v_lshlrev_b32 v215, 7, v215
    v_lshrrev_b32 v214, 1, v214
    v_xor_b32 v214, s71, v214
    v_lshl_add_u32 v215, v214, 6, v215
    v_and_b32 v216, 1, v223
    v_lshl_add_u32 v215, v216, 5, v215
    v_and_b32 v216, 3, v222
    v_lshl_add_u32 v243, v216, 3, v215
    v_mov_b32 v244, v243
    v_add_u32 v243, 0x4000, v243
    v_add_u32 v245, 0x10000, v241
    v_add_u32 v246, 0x10000, v242
    v_add_u32 v247, 0x10000, v243
    v_add_u32 v249, 0x20000, v241
    v_add_u32 v250, 0x20000, v242
    v_add_u32 v251, 0x20000, v243
    v_add_u32 v248, 0x4000, v244
    s_lshl_b32 s72, s70, 12
    s_add_u32 s72, s72, 0xc000
    v_lshl_add_u32 v218, v1, 4, s72
    s_cmp_ge_u32 s66, 4
    s_cbranch_scc1 KB_LD
    v_xor_b32 v196, 0x40, v241
    v_xor_b32 v197, 0x40, v242
    v_xor_b32 v198, 0x40, v245
    v_xor_b32 v199, 0x40, v246
    v_xor_b32 v200, 0x40, v249
    v_xor_b32 v201, 0x40, v250
    s_waitcnt vmcnt(4)
    s_barrier
    ds_read_b128 v[148:151], v229 offset:0
    ds_read_b64_tr_b16 v[4:5], v241 offset:0
    ds_read_b64_tr_b16 v[6:7], v241 offset:1024
    ds_read_b64_tr_b16 v[8:9], v242 offset:0
    ds_read_b64_tr_b16 v[10:11], v242 offset:1024
    ds_read_b64_tr_b16 v[12:13], v196 offset:0
    ds_read_b64_tr_b16 v[14:15], v196 offset:1024
    ds_read_b64_tr_b16 v[16:17], v197 offset:0
    ds_read_b64_tr_b16 v[18:19], v197 offset:1024
    ds_read_b128 v[152:155], v230 offset:0
    ds_read_b64_tr_b16 v[20:21], v241 offset:4096
    ds_read_b64_tr_b16 v[22:23], v241 offset:5120
    s_waitcnt lgkmcnt(9)
    v_mfma_f32_32x32x16_bf16 v[36:51], v[148:151], v[4:7], 0
    ds_read_b64_tr_b16 v[24:25], v242 offset:4096
    ds_read_b64_tr_b16 v[26:27], v242 offset:5120
    s_waitcnt lgkmcnt(9)
    v_mfma_f32_32x32x16_bf16 v[52:67], v[148:151], v[8:11], 0
    ds_read_b64_tr_b16 v[28:29], v196 offset:4096
    ds_read_b64_tr_b16 v[30:31], v196 offset:5120
    s_waitcnt lgkmcnt(9)
    v_mfma_f32_32x32x16_bf16 v[116:131], v[148:151], v[12:15], 0
    ds_read_b64_tr_b16 v[32:33], v197 offset:4096
    ds_read_b64_tr_b16 v[34:35], v197 offset:5120
    s_waitcnt lgkmcnt(9)
    v_mfma_f32_32x32x16_bf16 v[132:147], v[148:151], v[16:19], 0
    ds_read_b128 v[156:159], v231 offset:0
    ds_read_b64_tr_b16 v[4:5], v241 offset:8192
    ds_read_b64_tr_b16 v[6:7], v241 offset:9216
    s_waitcnt lgkmcnt(9)
    v_mfma_f32_32x32x16_bf16 v[36:51], v[152:155], v[20:23], v[36:51]
    ds_read_b64_tr_b16 v[8:9], v242 offset:8192
    ds_read_b64_tr_b16 v[10:11], v242 offset:9216
    s_waitcnt lgkmcnt(9)
    v_mfma_f32_32x32x16_bf16 v[52:67], v[152:155], v[24:27], v[52:67]
    ds_read_b64_tr_b16 v[12:13], v196 offset:8192
    ds_read_b64_tr_b16 v[14:15], v196 offset:9216
    s_waitcnt lgkmcnt(9)
    v_mfma_f32_32x32x16_bf16 v[116:131], v[152:155], v[28:31], v[116:131]
    ds_read_b64_tr_b16 v[16:17], v197 offset:8192
    ds_read_b64_tr_b16 v[18:19], v197 offset:9216
    s_waitcnt lgkmcnt(9)
    v_mfma_f32_32x32x16_bf16 v[132:147], v[152:155], v[32:35], v[132:147]
    ds_read_b128 v[160:163], v232 offset:0
    ds_read_b64_tr_b16 v[20:21], v241 offset:12288
    ds_read_b64_tr_b16 v[22:23], v241 offset:13312
    s_waitcnt lgkmcnt(9)
    v_mfma_f32_32x32x16_bf16 v[36:51], v[156:159], v[4:7], v[36:51]
    ds_read_b64_tr_b16 v[24:25], v242 offset:12288
    ds_read_b64_tr_b16 v[26:27], v242 offset:13312
    s_waitcnt lgkmcnt(9)
    v_mfma_f32_32x32x16_bf16 v[52:67], v[156:159], v[8:11], v[52:67]
    ds_read_b64_tr_b16 v[28:29], v196 offset:12288
    ds_read_b64_tr_b16 v[30:31], v196 offset:13312
    s_waitcnt lgkmcnt(9)
    v_mfma_f32_32x32x16_bf16 v[116:131], v[156:159], v[12:15], v[116:131]
    ds_read_b64_tr_b16 v[32:33], v197 offset:12288
    ds_read_b64_tr_b16 v[34:35], v197 offset:13312
    s_waitcnt lgkmcnt(9)
    v_mfma_f32_32x32x16_bf16 v[132:147], v[156:159], v[16:19], v[132:147]
    s_waitcnt vmcnt(0)
    s_barrier
    ds_read_b128 v[164:167], v229 offset:32768
    ds_read_b64_tr_b16 v[4:5], v241 offset:32768
    ds_read_b64_tr_b16 v[6:7], v241 offset:33792
    s_waitcnt lgkmcnt(9)
    v_mfma_f32_32x32x16_bf16 v[36:51], v[160:163], v[20:23], v[36:51]
    ds_read_b64_tr_b16 v[8:9], v242 offset:32768
    ds_read_b64_tr_b16 v[10:11], v242 offset:33792
    s_waitcnt lgkmcnt(9)
    v_mfma_f32_32x32x16_bf16 v[52:67], v[160:163], v[24:27], v[52:67]
    ds_read_b64_tr_b16 v[12:13], v196 offset:32768
    ds_read_b64_tr_b16 v[14:15], v196 offset:33792
    s_waitcnt lgkmcnt(9)
    v_mfma_f32_32x32x16_bf16 v[116:131], v[160:163], v[28:31], v[116:131]
    ds_read_b64_tr_b16 v[16:17], v197 offset:32768
    ds_read_b64_tr_b16 v[18:19], v197 offset:33792
    s_waitcnt lgkmcnt(9)
    v_mfma_f32_32x32x16_bf16 v[132:147], v[160:163], v[32:35], v[132:147]
    ds_read_b128 v[168:171], v230 offset:32768
    ds_read_b64_tr_b16 v[20:21], v241 offset:36864
    ds_read_b64_tr_b16 v[22:23], v241 offset:37888
    s_waitcnt lgkmcnt(9)
    v_mfma_f32_32x32x16_bf16 v[36:51], v[164:167], v[4:7], v[36:51]
    ds_read_b64_tr_b16 v[24:25], v242 offset:36864
    ds_read_b64_tr_b16 v[26:27], v242 offset:37888
    s_waitcnt lgkmcnt(9)
    v_mfma_f32_32x32x16_bf16 v[52:67], v[164:167], v[8:11], v[52:67]
    ds_read_b64_tr_b16 v[28:29], v196 offset:36864
    ds_read_b64_tr_b16 v[30:31], v196 offset:37888
    s_waitcnt lgkmcnt(9)
    v_mfma_f32_32x32x16_bf16 v[116:131], v[164:167], v[12:15], v[116:131]
    ds_read_b64_tr_b16 v[32:33], v197 offset:36864
    ds_read_b64_tr_b16 v[34:35], v197 offset:37888
    s_waitcnt lgkmcnt(9)
    v_mfma_f32_32x32x16_bf16 v[132:147], v[164:167], v[16:19], v[132:147]
    ds_read_b128 v[172:175], v231 offset:32768
    ds_read_b64_tr_b16 v[4:5], v241 offset:40960
    ds_read_b64_tr_b16 v[6:7], v241 offset:41984
    s_waitcnt lgkmcnt(9)
    v_mfma_f32_32x32x16_bf16 v[36:51], v[168:171], v[20:23], v[36:51]
    ds_read_b64_tr_b16 v[8:9], v242 offset:40960
    ds_read_b64_tr_b16 v[10:11], v242 offset:41984
    s_waitcnt lgkmcnt(9)
    v_mfma_f32_32x32x16_bf16 v[52:67], v[168:171], v[24:27], v[52:67]
    ds_read_b64_tr_b16 v[12:13], v196 offset:40960
    ds_read_b64_tr_b16 v[14:15], v196 offset:41984
    s_waitcnt lgkmcnt(9)
    v_mfma_f32_32x32x16_bf16 v[116:131], v[168:171], v[28:31], v[116:131]
    ds_read_b64_tr_b16 v[16:17], v197 offset:40960
    ds_read_b64_tr_b16 v[18:19], v197 offset:41984
    s_waitcnt lgkmcnt(9)
    v_mfma_f32_32x32x16_bf16 v[132:147], v[168:171], v[32:35], v[132:147]
    ds_read_b128 v[176:179], v232 offset:32768
    ds_read_b64_tr_b16 v[20:21], v241 offset:45056
    ds_read_b64_tr_b16 v[22:23], v241 offset:46080
    s_waitcnt lgkmcnt(9)
    v_mfma_f32_32x32x16_bf16 v[36:51], v[172:175], v[4:7], v[36:51]
    ds_read_b64_tr_b16 v[24:25], v242 offset:45056
    ds_read_b64_tr_b16 v[26:27], v242 offset:46080
    s_waitcnt lgkmcnt(9)
    v_mfma_f32_32x32x16_bf16 v[52:67], v[172:175], v[8:11], v[52:67]
    ds_read_b64_tr_b16 v[28:29], v196 offset:45056
    ds_read_b64_tr_b16 v[30:31], v196 offset:46080
    s_waitcnt lgkmcnt(9)
    v_mfma_f32_32x32x16_bf16 v[116:131], v[172:175], v[12:15], v[116:131]
    ds_read_b64_tr_b16 v[32:33], v197 offset:45056
    ds_read_b64_tr_b16 v[34:35], v197 offset:46080
    s_waitcnt lgkmcnt(9)
    v_mfma_f32_32x32x16_bf16 v[132:147], v[172:175], v[16:19], v[132:147]
    s_barrier
    ds_read_b128 v[180:183], v233 offset:0
    ds_read_b64_tr_b16 v[4:5], v245 offset:0
    ds_read_b64_tr_b16 v[6:7], v245 offset:1024
    s_waitcnt lgkmcnt(9)
    v_mfma_f32_32x32x16_bf16 v[36:51], v[176:179], v[20:23], v[36:51]
    ds_read_b64_tr_b16 v[8:9], v246 offset:0
    ds_read_b64_tr_b16 v[10:11], v246 offset:1024
    s_waitcnt lgkmcnt(9)
    v_mfma_f32_32x32x16_bf16 v[52:67], v[176:179], v[24:27], v[52:67]
    ds_read_b64_tr_b16 v[12:13], v198 offset:0
    ds_read_b64_tr_b16 v[14:15], v198 offset:1024
    s_waitcnt lgkmcnt(9)
    v_mfma_f32_32x32x16_bf16 v[116:131], v[176:179], v[28:31], v[116:131]
    ds_read_b64_tr_b16 v[16:17], v199 offset:0
    ds_read_b64_tr_b16 v[18:19], v199 offset:1024
    s_waitcnt lgkmcnt(9)
    v_mfma_f32_32x32x16_bf16 v[132:147], v[176:179], v[32:35], v[132:147]
    ds_read_b128 v[184:187], v234 offset:0
    ds_read_b64_tr_b16 v[20:21], v245 offset:4096
    ds_read_b64_tr_b16 v[22:23], v245 offset:5120
    s_waitcnt lgkmcnt(9)
    v_mfma_f32_32x32x16_bf16 v[36:51], v[180:183], v[4:7], v[36:51]
    ds_read_b64_tr_b16 v[24:25], v246 offset:4096
    ds_read_b64_tr_b16 v[26:27], v246 offset:5120
    s_waitcnt lgkmcnt(9)
    v_mfma_f32_32x32x16_bf16 v[52:67], v[180:183], v[8:11], v[52:67]
    ds_read_b64_tr_b16 v[28:29], v198 offset:4096
    ds_read_b64_tr_b16 v[30:31], v198 offset:5120
    s_waitcnt lgkmcnt(9)
    v_mfma_f32_32x32x16_bf16 v[116:131], v[180:183], v[12:15], v[116:131]
    ds_read_b64_tr_b16 v[32:33], v199 offset:4096
    ds_read_b64_tr_b16 v[34:35], v199 offset:5120
    s_waitcnt lgkmcnt(9)
    v_mfma_f32_32x32x16_bf16 v[132:147], v[180:183], v[16:19], v[132:147]
    ds_read_b128 v[188:191], v235 offset:0
    ds_read_b64_tr_b16 v[4:5], v245 offset:8192
    ds_read_b64_tr_b16 v[6:7], v245 offset:9216
    s_waitcnt lgkmcnt(9)
    v_mfma_f32_32x32x16_bf16 v[36:51], v[184:187], v[20:23], v[36:51]
    ds_read_b64_tr_b16 v[8:9], v246 offset:8192
    ds_read_b64_tr_b16 v[10:11], v246 offset:9216
    s_waitcnt lgkmcnt(9)
    v_mfma_f32_32x32x16_bf16 v[52:67], v[184:187], v[24:27], v[52:67]
    ds_read_b64_tr_b16 v[12:13], v198 offset:8192
    ds_read_b64_tr_b16 v[14:15], v198 offset:9216
    s_waitcnt lgkmcnt(9)
    v_mfma_f32_32x32x16_bf16 v[116:131], v[184:187], v[28:31], v[116:131]
    ds_read_b64_tr_b16 v[16:17], v199 offset:8192
    ds_read_b64_tr_b16 v[18:19], v199 offset:9216
    s_waitcnt lgkmcnt(9)
    v_mfma_f32_32x32x16_bf16 v[132:147], v[184:187], v[32:35], v[132:147]
    ds_read_b128 v[192:195], v236 offset:0
    ds_read_b64_tr_b16 v[20:21], v245 offset:12288
    ds_read_b64_tr_b16 v[22:23], v245 offset:13312
    s_waitcnt lgkmcnt(9)
    v_mfma_f32_32x32x16_bf16 v[36:51], v[188:191], v[4:7], v[36:51]
    ds_read_b64_tr_b16 v[24:25], v246 offset:12288
    ds_read_b64_tr_b16 v[26:27], v246 offset:13312
    s_waitcnt lgkmcnt(9)
    v_mfma_f32_32x32x16_bf16 v[52:67], v[188:191], v[8:11], v[52:67]
    ds_read_b64_tr_b16 v[28:29], v198 offset:12288
    ds_read_b64_tr_b16 v[30:31], v198 offset:13312
    s_waitcnt lgkmcnt(9)
    v_mfma_f32_32x32x16_bf16 v[116:131], v[188:191], v[12:15], v[116:131]
    ds_read_b64_tr_b16 v[32:33], v199 offset:12288
    ds_read_b64_tr_b16 v[34:35], v199 offset:13312
    s_waitcnt lgkmcnt(9)
    v_mfma_f32_32x32x16_bf16 v[132:147], v[188:191], v[16:19], v[132:147]
    s_barrier
    ds_read_b128 v[4:7], v233 offset:32768
    ds_read_b64_tr_b16 v[8:9], v245 offset:32768
    ds_read_b64_tr_b16 v[10:11], v245 offset:33792
    s_waitcnt lgkmcnt(9)
    v_mfma_f32_32x32x16_bf16 v[36:51], v[192:195], v[20:23], v[36:51]
    ds_read_b64_tr_b16 v[12:13], v246 offset:32768
    ds_read_b64_tr_b16 v[14:15], v246 offset:33792
    s_waitcnt lgkmcnt(9)
    v_mfma_f32_32x32x16_bf16 v[52:67], v[192:195], v[24:27], v[52:67]
    ds_read_b64_tr_b16 v[16:17], v198 offset:32768
    ds_read_b64_tr_b16 v[18:19], v198 offset:33792
    s_waitcnt lgkmcnt(9)
    v_mfma_f32_32x32x16_bf16 v[116:131], v[192:195], v[28:31], v[116:131]
    ds_read_b64_tr_b16 v[20:21], v199 offset:32768
    ds_read_b64_tr_b16 v[22:23], v199 offset:33792
    s_waitcnt lgkmcnt(9)
    v_mfma_f32_32x32x16_bf16 v[132:147], v[192:195], v[32:35], v[132:147]
    ds_read_b128 v[24:27], v234 offset:32768
    ds_read_b64_tr_b16 v[28:29], v245 offset:36864
    ds_read_b64_tr_b16 v[30:31], v245 offset:37888
    s_waitcnt lgkmcnt(9)
    v_mfma_f32_32x32x16_bf16 v[36:51], v[4:7], v[8:11], v[36:51]
    ds_read_b64_tr_b16 v[32:33], v246 offset:36864
    ds_read_b64_tr_b16 v[34:35], v246 offset:37888
    s_waitcnt lgkmcnt(9)
    v_mfma_f32_32x32x16_bf16 v[52:67], v[4:7], v[12:15], v[52:67]
    ds_read_b64_tr_b16 v[8:9], v198 offset:36864
    ds_read_b64_tr_b16 v[10:11], v198 offset:37888
    s_waitcnt lgkmcnt(9)
    v_mfma_f32_32x32x16_bf16 v[116:131], v[4:7], v[16:19], v[116:131]
    ds_read_b64_tr_b16 v[12:13], v199 offset:36864
    ds_read_b64_tr_b16 v[14:15], v199 offset:37888
    s_waitcnt lgkmcnt(9)
    v_mfma_f32_32x32x16_bf16 v[132:147], v[4:7], v[20:23], v[132:147]
    ds_read_b128 v[16:19], v235 offset:32768
    ds_read_b64_tr_b16 v[4:5], v245 offset:40960
    ds_read_b64_tr_b16 v[6:7], v245 offset:41984
    s_waitcnt lgkmcnt(9)
    v_mfma_f32_32x32x16_bf16 v[36:51], v[24:27], v[28:31], v[36:51]
    ds_read_b64_tr_b16 v[20:21], v246 offset:40960
    ds_read_b64_tr_b16 v[22:23], v246 offset:41984
    s_waitcnt lgkmcnt(9)
    v_mfma_f32_32x32x16_bf16 v[52:67], v[24:27], v[32:35], v[52:67]
    ds_read_b64_tr_b16 v[28:29], v198 offset:40960
    ds_read_b64_tr_b16 v[30:31], v198 offset:41984
    s_waitcnt lgkmcnt(9)
    v_mfma_f32_32x32x16_bf16 v[116:131], v[24:27], v[8:11], v[116:131]
    ds_read_b64_tr_b16 v[32:33], v199 offset:40960
    ds_read_b64_tr_b16 v[34:35], v199 offset:41984
    s_waitcnt lgkmcnt(9)
    v_mfma_f32_32x32x16_bf16 v[132:147], v[24:27], v[12:15], v[132:147]
    ds_read_b128 v[8:11], v236 offset:32768
    ds_read_b64_tr_b16 v[24:25], v245 offset:45056
    ds_read_b64_tr_b16 v[26:27], v245 offset:46080
    s_waitcnt lgkmcnt(9)
    v_mfma_f32_32x32x16_bf16 v[36:51], v[16:19], v[4:7], v[36:51]
    ds_read_b64_tr_b16 v[12:13], v246 offset:45056
    ds_read_b64_tr_b16 v[14:15], v246 offset:46080
    s_waitcnt lgkmcnt(9)
    v_mfma_f32_32x32x16_bf16 v[52:67], v[16:19], v[20:23], v[52:67]
    ds_read_b64_tr_b16 v[4:5], v198 offset:45056
    ds_read_b64_tr_b16 v[6:7], v198 offset:46080
    s_waitcnt lgkmcnt(9)
    v_mfma_f32_32x32x16_bf16 v[116:131], v[16:19], v[28:31], v[116:131]
    ds_read_b64_tr_b16 v[20:21], v199 offset:45056
    ds_read_b64_tr_b16 v[22:23], v199 offset:46080
    s_waitcnt lgkmcnt(9)
    v_mfma_f32_32x32x16_bf16 v[132:147], v[16:19], v[32:35], v[132:147]
    s_barrier
    ds_read_b128 v[28:31], v237 offset:0
    buffer_load_dwordx2 v[220:221], v254, s[20:23], 0 offen sc1
    ds_read_b64_tr_b16 v[16:17], v249 offset:0
    ds_read_b64_tr_b16 v[18:19], v249 offset:1024
    s_waitcnt lgkmcnt(9)
    v_mfma_f32_32x32x16_bf16 v[36:51], v[8:11], v[24:27], v[36:51]
    ds_read_b64_tr_b16 v[32:33], v250 offset:0
    ds_read_b64_tr_b16 v[34:35], v250 offset:1024
    s_waitcnt lgkmcnt(9)
    v_mfma_f32_32x32x16_bf16 v[52:67], v[8:11], v[12:15], v[52:67]
    ds_read_b64_tr_b16 v[24:25], v200 offset:0
    ds_read_b64_tr_b16 v[26:27], v200 offset:1024
    s_waitcnt lgkmcnt(9)
    v_mfma_f32_32x32x16_bf16 v[116:131], v[8:11], v[4:7], v[116:131]
    ds_read_b64_tr_b16 v[12:13], v201 offset:0
    ds_read_b64_tr_b16 v[14:15], v201 offset:1024
    s_waitcnt lgkmcnt(9)
    v_mfma_f32_32x32x16_bf16 v[132:147], v[8:11], v[20:23], v[132:147]
    ds_read_b128 v[4:7], v238 offset:0
    ds_read_b64_tr_b16 v[8:9], v249 offset:4096
    ds_read_b64_tr_b16 v[10:11], v249 offset:5120
    s_waitcnt lgkmcnt(9)
    v_mfma_f32_32x32x16_bf16 v[36:51], v[28:31], v[16:19], v[36:51]
    ds_read_b64_tr_b16 v[20:21], v250 offset:4096
    ds_read_b64_tr_b16 v[22:23], v250 offset:5120
    s_waitcnt lgkmcnt(9)
    v_mfma_f32_32x32x16_bf16 v[52:67], v[28:31], v[32:35], v[52:67]
    ds_read_b64_tr_b16 v[16:17], v200 offset:4096
    ds_read_b64_tr_b16 v[18:19], v200 offset:5120
    s_waitcnt lgkmcnt(9)
    v_mfma_f32_32x32x16_bf16 v[116:131], v[28:31], v[24:27], v[116:131]
    ds_read_b64_tr_b16 v[32:33], v201 offset:4096
    ds_read_b64_tr_b16 v[34:35], v201 offset:5120
    s_waitcnt lgkmcnt(9)
    v_mfma_f32_32x32x16_bf16 v[132:147], v[28:31], v[12:15], v[132:147]
    ds_read_b128 v[24:27], v239 offset:0
    ds_read_b64_tr_b16 v[28:29], v249 offset:8192
    ds_read_b64_tr_b16 v[30:31], v249 offset:9216
    s_waitcnt lgkmcnt(9)
    v_mfma_f32_32x32x16_bf16 v[36:51], v[4:7], v[8:11], v[36:51]
    ds_read_b64_tr_b16 v[12:13], v250 offset:8192
    ds_read_b64_tr_b16 v[14:15], v250 offset:9216
    s_waitcnt lgkmcnt(9)
    v_mfma_f32_32x32x16_bf16 v[52:67], v[4:7], v[20:23], v[52:67]
    ds_read_b64_tr_b16 v[8:9], v200 offset:8192
    ds_read_b64_tr_b16 v[10:11], v200 offset:9216
    s_waitcnt lgkmcnt(9)
    v_mfma_f32_32x32x16_bf16 v[116:131], v[4:7], v[16:19], v[116:131]
    ds_read_b64_tr_b16 v[20:21], v201 offset:8192
    ds_read_b64_tr_b16 v[22:23], v201 offset:9216
    s_waitcnt lgkmcnt(9)
    v_mfma_f32_32x32x16_bf16 v[132:147], v[4:7], v[32:35], v[132:147]
    ds_read_b128 v[16:19], v240 offset:0
    ds_read_b64_tr_b16 v[4:5], v249 offset:12288
    ds_read_b64_tr_b16 v[6:7], v249 offset:13312
    s_waitcnt lgkmcnt(9)
    v_mfma_f32_32x32x16_bf16 v[36:51], v[24:27], v[28:31], v[36:51]
    ds_read_b64_tr_b16 v[32:33], v250 offset:12288
    ds_read_b64_tr_b16 v[34:35], v250 offset:13312
    s_waitcnt lgkmcnt(9)
    v_mfma_f32_32x32x16_bf16 v[52:67], v[24:27], v[12:15], v[52:67]
    ds_read_b64_tr_b16 v[28:29], v200 offset:12288
    ds_read_b64_tr_b16 v[30:31], v200 offset:13312
    s_waitcnt lgkmcnt(9)
    v_mfma_f32_32x32x16_bf16 v[116:131], v[24:27], v[8:11], v[116:131]
    ds_read_b64_tr_b16 v[12:13], v201 offset:12288
    ds_read_b64_tr_b16 v[14:15], v201 offset:13312
    s_waitcnt lgkmcnt(9)
    v_mfma_f32_32x32x16_bf16 v[132:147], v[24:27], v[20:23], v[132:147]
    s_barrier
    ds_read_b128 v[8:11], v229 offset:0
    ds_read_b64_tr_b16 v[24:25], v241 offset:0
    ds_read_b64_tr_b16 v[26:27], v241 offset:1024
    s_waitcnt lgkmcnt(9)
    v_mfma_f32_32x32x16_bf16 v[36:51], v[16:19], v[4:7], v[36:51]
    ds_read_b64_tr_b16 v[20:21], v242 offset:0
    ds_read_b64_tr_b16 v[22:23], v242 offset:1024
    s_waitcnt lgkmcnt(9)
    v_mfma_f32_32x32x16_bf16 v[52:67], v[16:19], v[32:35], v[52:67]
    ds_read_b64_tr_b16 v[4:5], v196 offset:0
    ds_read_b64_tr_b16 v[6:7], v196 offset:1024
    s_waitcnt lgkmcnt(9)
    v_mfma_f32_32x32x16_bf16 v[116:131], v[16:19], v[28:31], v[116:131]
    ds_read_b64_tr_b16 v[32:33], v197 offset:0
    ds_read_b64_tr_b16 v[34:35], v197 offset:1024
    s_waitcnt lgkmcnt(9)
    v_mfma_f32_32x32x16_bf16 v[132:147], v[16:19], v[12:15], v[132:147]
    ds_read_b128 v[28:31], v230 offset:0
    ds_read_b64_tr_b16 v[16:17], v241 offset:4096
    ds_read_b64_tr_b16 v[18:19], v241 offset:5120
    s_waitcnt lgkmcnt(9)
    v_mfma_f32_32x32x16_bf16 v[36:51], v[8:11], v[24:27], v[36:51]
    ds_read_b64_tr_b16 v[12:13], v242 offset:4096
    ds_read_b64_tr_b16 v[14:15], v242 offset:5120
    s_waitcnt lgkmcnt(9)
    v_mfma_f32_32x32x16_bf16 v[52:67], v[8:11], v[20:23], v[52:67]
    ds_read_b64_tr_b16 v[24:25], v196 offset:4096
    ds_read_b64_tr_b16 v[26:27], v196 offset:5120
    s_waitcnt lgkmcnt(9)
    v_mfma_f32_32x32x16_bf16 v[116:131], v[8:11], v[4:7], v[116:131]
    ds_read_b64_tr_b16 v[20:21], v197 offset:4096
    ds_read_b64_tr_b16 v[22:23], v197 offset:5120
    s_waitcnt lgkmcnt(9)
    v_mfma_f32_32x32x16_bf16 v[132:147], v[8:11], v[32:35], v[132:147]
    ds_read_b128 v[4:7], v231 offset:0
    ds_read_b64_tr_b16 v[8:9], v241 offset:8192
    ds_read_b64_tr_b16 v[10:11], v241 offset:9216
    s_waitcnt lgkmcnt(9)
    v_mfma_f32_32x32x16_bf16 v[36:51], v[28:31], v[16:19], v[36:51]
    ds_read_b64_tr_b16 v[32:33], v242 offset:8192
    ds_read_b64_tr_b16 v[34:35], v242 offset:9216
    s_waitcnt lgkmcnt(9)
    v_mfma_f32_32x32x16_bf16 v[52:67], v[28:31], v[12:15], v[52:67]
    ds_read_b64_tr_b16 v[16:17], v196 offset:8192
    ds_read_b64_tr_b16 v[18:19], v196 offset:9216
    s_waitcnt lgkmcnt(9)
    v_mfma_f32_32x32x16_bf16 v[116:131], v[28:31], v[24:27], v[116:131]
    ds_read_b64_tr_b16 v[12:13], v197 offset:8192
    ds_read_b64_tr_b16 v[14:15], v197 offset:9216
    s_waitcnt lgkmcnt(9)
    v_mfma_f32_32x32x16_bf16 v[132:147], v[28:31], v[20:23], v[132:147]
    ds_read_b128 v[24:27], v232 offset:0
    ds_read_b64_tr_b16 v[28:29], v241 offset:12288
    ds_read_b64_tr_b16 v[30:31], v241 offset:13312
    s_waitcnt lgkmcnt(9)
    v_mfma_f32_32x32x16_bf16 v[36:51], v[4:7], v[8:11], v[36:51]
    ds_read_b64_tr_b16 v[20:21], v242 offset:12288
    ds_read_b64_tr_b16 v[22:23], v242 offset:13312
    s_waitcnt lgkmcnt(9)
    v_mfma_f32_32x32x16_bf16 v[52:67], v[4:7], v[32:35], v[52:67]
    ds_read_b64_tr_b16 v[8:9], v196 offset:12288
    ds_read_b64_tr_b16 v[10:11], v196 offset:13312
    s_waitcnt lgkmcnt(9)
    v_mfma_f32_32x32x16_bf16 v[116:131], v[4:7], v[16:19], v[116:131]
    ds_read_b64_tr_b16 v[32:33], v197 offset:12288
    ds_read_b64_tr_b16 v[34:35], v197 offset:13312
    s_waitcnt lgkmcnt(9)
    v_mfma_f32_32x32x16_bf16 v[132:147], v[4:7], v[12:15], v[132:147]
    s_barrier
    ds_read_b128 v[16:19], v229 offset:32768
    ds_read_b64_tr_b16 v[4:5], v241 offset:32768
    ds_read_b64_tr_b16 v[6:7], v241 offset:33792
    s_waitcnt lgkmcnt(9)
    v_mfma_f32_32x32x16_bf16 v[36:51], v[24:27], v[28:31], v[36:51]
    ds_read_b64_tr_b16 v[12:13], v242 offset:32768
    ds_read_b64_tr_b16 v[14:15], v242 offset:33792
    s_waitcnt lgkmcnt(9)
    v_mfma_f32_32x32x16_bf16 v[52:67], v[24:27], v[20:23], v[52:67]
    ds_read_b64_tr_b16 v[28:29], v196 offset:32768
    ds_read_b64_tr_b16 v[30:31], v196 offset:33792
    s_waitcnt lgkmcnt(9)
    v_mfma_f32_32x32x16_bf16 v[116:131], v[24:27], v[8:11], v[116:131]
    ds_read_b64_tr_b16 v[20:21], v197 offset:32768
    ds_read_b64_tr_b16 v[22:23], v197 offset:33792
    s_waitcnt lgkmcnt(9)
    v_mfma_f32_32x32x16_bf16 v[132:147], v[24:27], v[32:35], v[132:147]
    ds_read_b128 v[8:11], v230 offset:32768
    ds_read_b64_tr_b16 v[24:25], v241 offset:36864
    ds_read_b64_tr_b16 v[26:27], v241 offset:37888
    s_waitcnt lgkmcnt(9)
    v_mfma_f32_32x32x16_bf16 v[36:51], v[16:19], v[4:7], v[36:51]
    ds_read_b64_tr_b16 v[32:33], v242 offset:36864
    ds_read_b64_tr_b16 v[34:35], v242 offset:37888
    s_waitcnt lgkmcnt(9)
    v_mfma_f32_32x32x16_bf16 v[52:67], v[16:19], v[12:15], v[52:67]
    ds_read_b64_tr_b16 v[4:5], v196 offset:36864
    ds_read_b64_tr_b16 v[6:7], v196 offset:37888
    s_waitcnt lgkmcnt(9)
    v_mfma_f32_32x32x16_bf16 v[116:131], v[16:19], v[28:31], v[116:131]
    ds_read_b64_tr_b16 v[12:13], v197 offset:36864
    ds_read_b64_tr_b16 v[14:15], v197 offset:37888
    s_waitcnt lgkmcnt(9)
    v_mfma_f32_32x32x16_bf16 v[132:147], v[16:19], v[20:23], v[132:147]
    ds_read_b128 v[28:31], v231 offset:32768
    ds_read_b64_tr_b16 v[16:17], v241 offset:40960
    ds_read_b64_tr_b16 v[18:19], v241 offset:41984
    s_waitcnt lgkmcnt(9)
    v_mfma_f32_32x32x16_bf16 v[36:51], v[8:11], v[24:27], v[36:51]
    ds_read_b64_tr_b16 v[20:21], v242 offset:40960
    ds_read_b64_tr_b16 v[22:23], v242 offset:41984
    s_waitcnt lgkmcnt(9)
    v_mfma_f32_32x32x16_bf16 v[52:67], v[8:11], v[32:35], v[52:67]
    ds_read_b64_tr_b16 v[24:25], v196 offset:40960
    ds_read_b64_tr_b16 v[26:27], v196 offset:41984
    s_waitcnt lgkmcnt(9)
    v_mfma_f32_32x32x16_bf16 v[116:131], v[8:11], v[4:7], v[116:131]
    ds_read_b64_tr_b16 v[32:33], v197 offset:40960
    ds_read_b64_tr_b16 v[34:35], v197 offset:41984
    s_waitcnt lgkmcnt(9)
    v_mfma_f32_32x32x16_bf16 v[132:147], v[8:11], v[12:15], v[132:147]
    ds_read_b128 v[4:7], v232 offset:32768
    ds_read_b64_tr_b16 v[8:9], v241 offset:45056
    ds_read_b64_tr_b16 v[10:11], v241 offset:46080
    s_waitcnt lgkmcnt(9)
    v_mfma_f32_32x32x16_bf16 v[36:51], v[28:31], v[16:19], v[36:51]
    ds_read_b64_tr_b16 v[12:13], v242 offset:45056
    ds_read_b64_tr_b16 v[14:15], v242 offset:46080
    s_waitcnt lgkmcnt(9)
    v_mfma_f32_32x32x16_bf16 v[52:67], v[28:31], v[20:23], v[52:67]
    ds_read_b64_tr_b16 v[16:17], v196 offset:45056
    ds_read_b64_tr_b16 v[18:19], v196 offset:46080
    s_waitcnt lgkmcnt(9)
    v_mfma_f32_32x32x16_bf16 v[116:131], v[28:31], v[24:27], v[116:131]
    ds_read_b64_tr_b16 v[20:21], v197 offset:45056
    ds_read_b64_tr_b16 v[22:23], v197 offset:46080
    s_waitcnt lgkmcnt(9)
    v_mfma_f32_32x32x16_bf16 v[132:147], v[28:31], v[32:35], v[132:147]
    s_barrier
    ds_read_b128 v[68:71], v233 offset:0
    ds_read_b64_tr_b16 v[24:25], v198 offset:0
    ds_read_b64_tr_b16 v[26:27], v198 offset:1024
    s_waitcnt lgkmcnt(9)
    v_mfma_f32_32x32x16_bf16 v[36:51], v[4:7], v[8:11], v[36:51]
    ds_read_b64_tr_b16 v[28:29], v199 offset:0
    ds_read_b64_tr_b16 v[30:31], v199 offset:1024
    s_waitcnt lgkmcnt(9)
    v_mfma_f32_32x32x16_bf16 v[52:67], v[4:7], v[12:15], v[52:67]
    ds_read_b128 v[72:75], v234 offset:0
    ds_read_b64_tr_b16 v[32:33], v198 offset:4096
    ds_read_b64_tr_b16 v[34:35], v198 offset:5120
    s_waitcnt lgkmcnt(10)
    v_mfma_f32_32x32x16_bf16 v[116:131], v[4:7], v[16:19], v[116:131]
    ds_read_b64_tr_b16 v[8:9], v199 offset:4096
    ds_read_b64_tr_b16 v[10:11], v199 offset:5120
    s_waitcnt lgkmcnt(10)
    v_mfma_f32_32x32x16_bf16 v[132:147], v[4:7], v[20:23], v[132:147]
    ds_read_b128 v[76:79], v235 offset:0
    ds_read_b64_tr_b16 v[12:13], v198 offset:8192
    ds_read_b64_tr_b16 v[14:15], v198 offset:9216
    s_waitcnt lgkmcnt(10)
    v_mfma_f32_32x32x16_bf16 v[116:131], v[68:71], v[24:27], v[116:131]
    ds_read_b64_tr_b16 v[16:17], v199 offset:8192
    ds_read_b64_tr_b16 v[18:19], v199 offset:9216
    s_waitcnt lgkmcnt(10)
    v_mfma_f32_32x32x16_bf16 v[132:147], v[68:71], v[28:31], v[132:147]
    ds_read_b128 v[80:83], v236 offset:0
    ds_read_b64_tr_b16 v[4:5], v198 offset:12288
    ds_read_b64_tr_b16 v[6:7], v198 offset:13312
    s_waitcnt lgkmcnt(10)
    v_mfma_f32_32x32x16_bf16 v[116:131], v[72:75], v[32:35], v[116:131]
    ds_read_b64_tr_b16 v[20:21], v199 offset:12288
    ds_read_b64_tr_b16 v[22:23], v199 offset:13312
    s_barrier
    s_waitcnt lgkmcnt(10)
    v_mfma_f32_32x32x16_bf16 v[132:147], v[72:75], v[8:11], v[132:147]
    ds_read_b64_tr_b16 v[24:25], v245 offset:0
    ds_read_b64_tr_b16 v[26:27], v245 offset:1024
    s_waitcnt lgkmcnt(9)
    v_mfma_f32_32x32x16_bf16 v[116:131], v[76:79], v[12:15], v[116:131]
    ds_read_b64_tr_b16 v[28:29], v246 offset:0
    ds_read_b64_tr_b16 v[30:31], v246 offset:1024
    s_waitcnt lgkmcnt(9)
    v_mfma_f32_32x32x16_bf16 v[132:147], v[76:79], v[16:19], v[132:147]
    ds_read_b64_tr_b16 v[32:33], v245 offset:4096
    ds_read_b64_tr_b16 v[34:35], v245 offset:5120
    s_waitcnt lgkmcnt(8)
    v_mfma_f32_32x32x16_bf16 v[116:131], v[80:83], v[4:7], v[116:131]
    ds_read_b64_tr_b16 v[8:9], v246 offset:4096
    ds_read_b64_tr_b16 v[10:11], v246 offset:5120
    s_waitcnt lgkmcnt(8)
    v_mfma_f32_32x32x16_bf16 v[132:147], v[80:83], v[20:23], v[132:147]
    ds_read_b64_tr_b16 v[12:13], v245 offset:8192
    ds_read_b64_tr_b16 v[14:15], v245 offset:9216
    s_waitcnt lgkmcnt(8)
    v_mfma_f32_32x32x16_bf16 v[36:51], v[68:71], v[24:27], v[36:51]
    ds_read_b64_tr_b16 v[16:17], v246 offset:8192
    ds_read_b64_tr_b16 v[18:19], v246 offset:9216
    s_waitcnt lgkmcnt(8)
    v_mfma_f32_32x32x16_bf16 v[52:67], v[68:71], v[28:31], v[52:67]
    ds_read_b64_tr_b16 v[4:5], v245 offset:12288
    ds_read_b64_tr_b16 v[6:7], v245 offset:13312
    v_cvt_pk_bf16_f32 v84, v116, v117
    v_cvt_pk_bf16_f32 v85, v118, v119
    v_cvt_pk_bf16_f32 v86, v120, v121
    v_cvt_pk_bf16_f32 v87, v122, v123
    ds_write_b128 v218, v[84:87] offset:0
    s_waitcnt lgkmcnt(9)
    v_mfma_f32_32x32x16_bf16 v[36:51], v[72:75], v[32:35], v[36:51]
    ds_read_b64_tr_b16 v[20:21], v246 offset:12288
    ds_read_b64_tr_b16 v[22:23], v246 offset:13312
    v_cvt_pk_bf16_f32 v88, v124, v125
    v_cvt_pk_bf16_f32 v89, v126, v127
    v_cvt_pk_bf16_f32 v90, v128, v129
    v_cvt_pk_bf16_f32 v91, v130, v131
    ds_write_b128 v218, v[88:91] offset:1024
    s_waitcnt lgkmcnt(10)
    v_mfma_f32_32x32x16_bf16 v[52:67], v[72:75], v[8:11], v[52:67]
    v_cvt_pk_bf16_f32 v92, v132, v133
    v_cvt_pk_bf16_f32 v93, v134, v135
    v_cvt_pk_bf16_f32 v94, v136, v137
    v_cvt_pk_bf16_f32 v95, v138, v139
    ds_write_b128 v218, v[92:95] offset:2048
    s_waitcnt lgkmcnt(9)
    v_mfma_f32_32x32x16_bf16 v[36:51], v[76:79], v[12:15], v[36:51]
    v_cvt_pk_bf16_f32 v96, v140, v141
    v_cvt_pk_bf16_f32 v97, v142, v143
    v_cvt_pk_bf16_f32 v98, v144, v145
    v_cvt_pk_bf16_f32 v99, v146, v147
    ds_write_b128 v218, v[96:99] offset:3072
    s_waitcnt lgkmcnt(8)
    v_mfma_f32_32x32x16_bf16 v[52:67], v[76:79], v[16:19], v[52:67]
    s_waitcnt lgkmcnt(0)
    s_barrier
    v_mfma_f32_32x32x16_bf16 v[36:51], v[80:83], v[4:7], v[36:51]
    v_mfma_f32_32x32x16_bf16 v[52:67], v[80:83], v[20:23], v[52:67]
    s_waitcnt vmcnt(0)
    s_barrier
    s_add_u32 m0, s76, 0x14000
    s_mul_i32 s78, s58, 0x30000
    buffer_load_dwordx4 v228, s[8:11], s78 offen lds
    s_add_u32 m0, s76, 0x16000
    s_mul_i32 s78, s59, 0x30000
    buffer_load_dwordx4 v228, s[8:11], s78 offen lds
    s_nop 2
    v_cvt_pk_bf16_f32 v84, v36, v37
    v_cvt_pk_bf16_f32 v85, v38, v39
    v_cvt_pk_bf16_f32 v86, v40, v41
    v_cvt_pk_bf16_f32 v87, v42, v43
    v_cvt_pk_bf16_f32 v88, v44, v45
    v_cvt_pk_bf16_f32 v89, v46, v47
    v_cvt_pk_bf16_f32 v90, v48, v49
    v_cvt_pk_bf16_f32 v91, v50, v51
    v_cvt_pk_bf16_f32 v100, v52, v53
    v_cvt_pk_bf16_f32 v101, v54, v55
    v_cvt_pk_bf16_f32 v102, v56, v57
    v_cvt_pk_bf16_f32 v103, v58, v59
    v_cvt_pk_bf16_f32 v104, v60, v61
    v_cvt_pk_bf16_f32 v105, v62, v63
    v_cvt_pk_bf16_f32 v106, v64, v65
    v_cvt_pk_bf16_f32 v107, v66, v67
    s_branch KB_G1E
KB_LD:
    s_nop 1
    v_subrev_u32 v4, 0x8000, v224
    v_subrev_u32 v5, 0x18000, v226
    v_subrev_u32 v6, 0x18000, v227
    v_subrev_u32 v7, 0x18000, v228
    s_waitcnt vmcnt(4) lgkmcnt(0)
    s_barrier
    ds_read_b128 v[148:151], v229 offset:0
    ds_read_b128 v[152:155], v230 offset:0
    ds_read_b128 v[156:159], v231 offset:0
    ds_read_b128 v[160:163], v232 offset:0
    s_add_u32 m0, s76, 0xf000
    s_mul_i32 s78, s60, 0x80
    buffer_load_dwordx4 v4, s[4:7], s78 offen lds
    s_add_u32 m0, s76, 0x10000
    s_nop 0
    buffer_load_dwordx4 v224, s[4:7], s78 offen lds
    s_add_u32 m0, s76, 0x11000
    s_mul_i32 s78, s60, 0x80
    s_add_u32 s78, s78, 0x10000
    buffer_load_dwordx4 v4, s[4:7], s78 offen lds
    s_add_u32 m0, s76, 0x12000
    s_nop 0
    buffer_load_dwordx4 v224, s[4:7], s78 offen lds
    s_add_u32 m0, s77, 0x12000
    s_mul_i32 s78, s60, 0x30000
    buffer_load_dwordx4 v5, s[8:11], s78 offen lds
    s_add_u32 m0, s77, 0x14000
    s_nop 0
    buffer_load_dwordx4 v226, s[8:11], s78 offen lds
    s_add_u32 m0, s77, 0x12400
    s_mul_i32 s78, s60, 0x30000
    buffer_load_dwordx4 v6, s[8:11], s78 offen lds
    s_add_u32 m0, s77, 0x14400
    s_nop 0
    buffer_load_dwordx4 v227, s[8:11], s78 offen lds
    s_add_u32 m0, s76, 0x17000
    s_mul_i32 s78, s61, 0x80
    buffer_load_dwordx4 v4, s[4:7], s78 offen lds
    s_add_u32 m0, s76, 0x18000
    s_nop 0
    buffer_load_dwordx4 v224, s[4:7], s78 offen lds
    s_add_u32 m0, s76, 0x19000
    s_mul_i32 s78, s61, 0x80
    s_add_u32 s78, s78, 0x10000
    buffer_load_dwordx4 v4, s[4:7], s78 offen lds
    s_add_u32 m0, s76, 0x1a000
    s_nop 0
    buffer_load_dwordx4 v224, s[4:7], s78 offen lds
    s_add_u32 m0, s77, 0x1a000
    s_mul_i32 s78, s61, 0x30000
    buffer_load_dwordx4 v5, s[8:11], s78 offen lds
    s_add_u32 m0, s77, 0x1c000
    s_nop 0
    buffer_load_dwordx4 v226, s[8:11], s78 offen lds
    s_add_u32 m0, s77, 0x1a400
    s_mul_i32 s78, s61, 0x30000
    buffer_load_dwordx4 v6, s[8:11], s78 offen lds
    s_add_u32 m0, s77, 0x1c400
    s_nop 0
    buffer_load_dwordx4 v227, s[8:11], s78 offen lds
    s_waitcnt vmcnt(16) lgkmcnt(0)
    s_barrier
    ds_read_b128 v[164:167], v229 offset:32768
    ds_read_b128 v[168:171], v230 offset:32768
    ds_read_b128 v[172:175], v231 offset:32768
    ds_read_b128 v[176:179], v232 offset:32768
    s_add_u32 m0, s76, 0x1f000
    s_mul_i32 s78, s62, 0x80
    buffer_load_dwordx4 v4, s[4:7], s78 offen lds
    s_add_u32 m0, s76, 0x20000
    s_nop 0
    buffer_load_dwordx4 v224, s[4:7], s78 offen lds
    s_add_u32 m0, s76, 0x21000
    s_mul_i32 s78, s62, 0x80
    s_add_u32 s78, s78, 0x10000
    buffer_load_dwordx4 v4, s[4:7], s78 offen lds
    s_add_u32 m0, s76, 0x22000
    s_nop 0
    buffer_load_dwordx4 v224, s[4:7], s78 offen lds
    s_add_u32 m0, s77, 0x22000
    s_mul_i32 s78, s62, 0x30000
    buffer_load_dwordx4 v5, s[8:11], s78 offen lds
    s_add_u32 m0, s77, 0x24000
    s_nop 0
    buffer_load_dwordx4 v226, s[8:11], s78 offen lds
    s_add_u32 m0, s77, 0x22400
    s_mul_i32 s78, s62, 0x30000
    buffer_load_dwordx4 v6, s[8:11], s78 offen lds
    s_add_u32 m0, s77, 0x24400
    s_nop 0
    buffer_load_dwordx4 v227, s[8:11], s78 offen lds
    s_waitcnt vmcnt(16) lgkmcnt(0)
    s_barrier
    ds_read_b128 v[180:183], v233 offset:0
    ds_read_b128 v[184:187], v234 offset:0
    ds_read_b128 v[188:191], v235 offset:0
    ds_read_b128 v[192:195], v236 offset:0
    s_add_u32 m0, s76, 0xfffff000
    s_mul_i32 s78, s63, 0x80
    buffer_load_dwordx4 v4, s[4:7], s78 offen lds
    s_add_u32 m0, s76, 0x0
    s_nop 0
    buffer_load_dwordx4 v224, s[4:7], s78 offen lds
    s_add_u32 m0, s76, 0x1000
    s_mul_i32 s78, s63, 0x80
    s_add_u32 s78, s78, 0x10000
    buffer_load_dwordx4 v4, s[4:7], s78 offen lds
    s_add_u32 m0, s76, 0x2000
    s_nop 0
    buffer_load_dwordx4 v224, s[4:7], s78 offen lds
    s_add_u32 m0, s77, 0x2000
    s_mul_i32 s78, s63, 0x30000
    buffer_load_dwordx4 v5, s[8:11], s78 offen lds
    s_add_u32 m0, s77, 0x4000
    s_nop 0
    buffer_load_dwordx4 v226, s[8:11], s78 offen lds
    s_add_u32 m0, s77, 0x2400
    s_mul_i32 s78, s63, 0x30000
    buffer_load_dwordx4 v6, s[8:11], s78 offen lds
    s_add_u32 m0, s77, 0x4400
    s_nop 0
    buffer_load_dwordx4 v227, s[8:11], s78 offen lds
    s_waitcnt vmcnt(16) lgkmcnt(0)
    s_barrier
    s_add_u32 m0, s76, 0x7000
    s_mul_i32 s78, s64, 0x80
    buffer_load_dwordx4 v4, s[4:7], s78 offen lds
    s_add_u32 m0, s76, 0x8000
    s_nop 0
    buffer_load_dwordx4 v224, s[4:7], s78 offen lds
    s_add_u32 m0, s76, 0x9000
    s_mul_i32 s78, s64, 0x80
    s_add_u32 s78, s78, 0x10000
    buffer_load_dwordx4 v4, s[4:7], s78 offen lds
    s_add_u32 m0, s76, 0xa000
    s_nop 0
    buffer_load_dwordx4 v224, s[4:7], s78 offen lds
    s_add_u32 m0, s77, 0xa000
    s_mul_i32 s78, s64, 0x30000
    buffer_load_dwordx4 v5, s[8:11], s78 offen lds
    s_add_u32 m0, s77, 0xc000
    s_nop 0
    buffer_load_dwordx4 v226, s[8:11], s78 offen lds
    s_add_u32 m0, s77, 0xa400
    s_mul_i32 s78, s64, 0x30000
    buffer_load_dwordx4 v6, s[8:11], s78 offen lds
    s_add_u32 m0, s77, 0xc400
    s_nop 0
    buffer_load_dwordx4 v227, s[8:11], s78 offen lds
    s_waitcnt vmcnt(16) lgkmcnt(0)
    s_barrier
    buffer_load_dwordx2 v[220:221], v254, s[20:23], 0 offen sc1
    s_add_u32 m0, s76, 0xf000
    s_mul_i32 s78, s65, 0x80
    buffer_load_dwordx4 v4, s[4:7], s78 offen lds
    s_add_u32 m0, s76, 0x10000
    s_nop 0
    buffer_load_dwordx4 v224, s[4:7], s78 offen lds
    s_add_u32 m0, s76, 0x11000
    s_mul_i32 s78, s65, 0x80
    s_add_u32 s78, s78, 0x10000
    buffer_load_dwordx4 v4, s[4:7], s78 offen lds
    s_add_u32 m0, s76, 0x12000
    s_nop 0
    buffer_load_dwordx4 v224, s[4:7], s78 offen lds
    s_add_u32 m0, s77, 0x12000
    s_mul_i32 s78, s65, 0x30000
    buffer_load_dwordx4 v5, s[8:11], s78 offen lds
    s_add_u32 m0, s77, 0x14000
    s_nop 0
    buffer_load_dwordx4 v226, s[8:11], s78 offen lds
    s_add_u32 m0, s77, 0x12400
    s_mul_i32 s78, s65, 0x30000
    buffer_load_dwordx4 v6, s[8:11], s78 offen lds
    s_add_u32 m0, s77, 0x14400
    s_nop 0
    buffer_load_dwordx4 v227, s[8:11], s78 offen lds
    s_waitcnt vmcnt(17) lgkmcnt(0)
    s_barrier
    s_add_u32 m0, s76, 0x1b000
    s_mul_i32 s78, s61, 0x30000
    buffer_load_dwordx4 v7, s[8:11], s78 offen lds
    s_add_u32 m0, s76, 0x1c000
    s_nop 0
    buffer_load_dwordx4 v228, s[8:11], s78 offen lds
    s_add_u32 m0, s76, 0x1d000
    s_mul_i32 s78, s62, 0x30000
    buffer_load_dwordx4 v7, s[8:11], s78 offen lds
    s_add_u32 m0, s76, 0x1e000
    s_nop 0
    buffer_load_dwordx4 v228, s[8:11], s78 offen lds
    s_waitcnt vmcnt(13) lgkmcnt(0)
    s_barrier
    s_add_u32 m0, s76, 0x23000
    s_mul_i32 s78, s63, 0x30000
    buffer_load_dwordx4 v7, s[8:11], s78 offen lds
    s_add_u32 m0, s76, 0x24000
    s_nop 0
    buffer_load_dwordx4 v228, s[8:11], s78 offen lds
    s_add_u32 m0, s76, 0x25000
    s_mul_i32 s78, s64, 0x30000
    buffer_load_dwordx4 v7, s[8:11], s78 offen lds
    s_add_u32 m0, s76, 0x26000
    s_nop 0
    buffer_load_dwordx4 v228, s[8:11], s78 offen lds
    s_waitcnt vmcnt(8) lgkmcnt(0)
    s_barrier
    s_add_u32 m0, s76, 0x3000
    s_mul_i32 s78, s65, 0x30000
    buffer_load_dwordx4 v7, s[8:11], s78 offen lds
    s_add_u32 m0, s76, 0x4000
    s_nop 0
    buffer_load_dwordx4 v228, s[8:11], s78 offen lds
    s_and_b32 s72, s67, 3
    s_lshl_b32 s72, s72, 17
    s_lshl_b32 s73, s70, 15
    s_add_u32 s72, s72, s73
    s_lshl_b32 s73, s68, 7
    s_add_u32 s72, s72, s73
    v_lshrrev_b32 v144, 1, v1
    v_lshlrev_b32 v144, 10, v144
    v_and_b32 v145, 1, v1
    v_lshl_add_u32 v144, v145, 6, v144
    buffer_load_dword v219, v144, s[28:31], s72 offen
KB_TW:
    s_nop 1
    s_barrier
    s_waitcnt vmcnt(18) lgkmcnt(0)
    s_barrier
    ds_read_b128 v[84:87], v218 offset:0
    ds_read_b128 v[88:91], v218 offset:1024
    ds_read_b128 v[100:103], v218 offset:2048
    ds_read_b128 v[104:107], v218 offset:3072
    s_waitcnt lgkmcnt(0)
    s_barrier
    s_add_u32 m0, s76, 0x14000
    s_mul_i32 s78, s58, 0x30000
    buffer_load_dwordx4 v228, s[8:11], s78 offen lds
    s_add_u32 m0, s76, 0x16000
    s_mul_i32 s78, s59, 0x30000
    buffer_load_dwordx4 v228, s[8:11], s78 offen lds
KB_G1E:
    s_nop 1
    s_mov_b32 s72, 0x3fb8aa3b
    s_mov_b32 s73, 0x358637bd
    v_mov_b32 v116, 0x3f803f80
    v_mov_b32 v117, 0x3f803f80
    v_mov_b32 v118, 0x3f803f80
    v_mov_b32 v119, 0x3f803f80
    s_mov_b32 s80, 0x3fb8aa3b
    s_mov_b32 s81, 1.0
    v_lshlrev_b32 v110, 16, v84
    v_and_b32 v111, 0xffff0000, v84
    v_pk_mul_f32 v[112:113], s[80:81], v[110:111] op_sel_hi:[0,1]
    v_exp_f32 v112, v112 clamp
    v_exp_f32 v113, v113 clamp
    v_pk_add_f32 v[110:111], s[80:81], v[110:111] op_sel:[1,0] op_sel_hi:[1,1]
    v_max_f32 v112, v112, v110
    v_max_f32 v113, v113, v111
    v_cvt_pk_bf16_f32 v92, v112, v113
    v_min_f32 v114, v112, v113
    v_lshlrev_b32 v110, 16, v85
    v_and_b32 v111, 0xffff0000, v85
    v_pk_mul_f32 v[112:113], s[80:81], v[110:111] op_sel_hi:[0,1]
    v_exp_f32 v112, v112 clamp
    v_exp_f32 v113, v113 clamp
    v_pk_add_f32 v[110:111], s[80:81], v[110:111] op_sel:[1,0] op_sel_hi:[1,1]
    v_max_f32 v112, v112, v110
    v_max_f32 v113, v113, v111
    v_cvt_pk_bf16_f32 v93, v112, v113
    v_min3_f32 v114, v112, v113, v114
    v_lshlrev_b32 v110, 16, v86
    v_and_b32 v111, 0xffff0000, v86
    v_pk_mul_f32 v[112:113], s[80:81], v[110:111] op_sel_hi:[0,1]
    v_exp_f32 v112, v112 clamp
    v_exp_f32 v113, v113 clamp
    v_pk_add_f32 v[110:111], s[80:81], v[110:111] op_sel:[1,0] op_sel_hi:[1,1]
    v_max_f32 v112, v112, v110
    v_max_f32 v113, v113, v111
    v_cvt_pk_bf16_f32 v94, v112, v113
    v_min3_f32 v114, v112, v113, v114
    v_lshlrev_b32 v110, 16, v87
    v_and_b32 v111, 0xffff0000, v87
    v_pk_mul_f32 v[112:113], s[80:81], v[110:111] op_sel_hi:[0,1]
    v_exp_f32 v112, v112 clamp
    v_exp_f32 v113, v113 clamp
    v_pk_add_f32 v[110:111], s[80:81], v[110:111] op_sel:[1,0] op_sel_hi:[1,1]
    v_max_f32 v112, v112, v110
    v_max_f32 v113, v113, v111
    v_cvt_pk_bf16_f32 v95, v112, v113
    v_min3_f32 v114, v112, v113, v114
    v_lshlrev_b32 v110, 16, v88
    v_and_b32 v111, 0xffff0000, v88
    v_pk_mul_f32 v[112:113], s[80:81], v[110:111] op_sel_hi:[0,1]
    v_exp_f32 v112, v112 clamp
    v_exp_f32 v113, v113 clamp
    v_pk_add_f32 v[110:111], s[80:81], v[110:111] op_sel:[1,0] op_sel_hi:[1,1]
    v_max_f32 v112, v112, v110
    v_max_f32 v113, v113, v111
    v_cvt_pk_bf16_f32 v96, v112, v113
    v_min3_f32 v114, v112, v113, v114
    v_lshlrev_b32 v110, 16, v89
    v_and_b32 v111, 0xffff0000, v89
    v_pk_mul_f32 v[112:113], s[80:81], v[110:111] op_sel_hi:[0,1]
    v_exp_f32 v112, v112 clamp
    v_exp_f32 v113, v113 clamp
    v_pk_add_f32 v[110:111], s[80:81], v[110:111] op_sel:[1,0] op_sel_hi:[1,1]
    v_max_f32 v112, v112, v110
    v_max_f32 v113, v113, v111
    v_cvt_pk_bf16_f32 v97, v112, v113
    v_min3_f32 v114, v112, v113, v114
    v_lshlrev_b32 v110, 16, v90
    v_and_b32 v111, 0xffff0000, v90
    v_pk_mul_f32 v[112:113], s[80:81], v[110:111] op_sel_hi:[0,1]
    v_exp_f32 v112, v112 clamp
    v_exp_f32 v113, v113 clamp
    v_pk_add_f32 v[110:111], s[80:81], v[110:111] op_sel:[1,0] op_sel_hi:[1,1]
    v_max_f32 v112, v112, v110
    v_max_f32 v113, v113, v111
    v_cvt_pk_bf16_f32 v98, v112, v113
    v_min3_f32 v114, v112, v113, v114
    v_lshlrev_b32 v110, 16, v91
    v_and_b32 v111, 0xffff0000, v91
    v_pk_mul_f32 v[112:113], s[80:81], v[110:111] op_sel_hi:[0,1]
    v_exp_f32 v112, v112 clamp
    v_exp_f32 v113, v113 clamp
    v_pk_add_f32 v[110:111], s[80:81], v[110:111] op_sel:[1,0] op_sel_hi:[1,1]
    v_max_f32 v112, v112, v110
    v_max_f32 v113, v113, v111
    v_cvt_pk_bf16_f32 v99, v112, v113
    v_min3_f32 v114, v112, v113, v114
    v_cmp_gt_f32 vcc, 0x3a800000, v114
    s_nop 2
    s_cbranch_vccz KB_K_PHF
    v_lshlrev_b32 v110, 16, v92
    v_and_b32 v111, 0xffff0000, v92
    v_add_f32 v110, s73, v110
    v_add_f32 v111, s73, v111
    v_cvt_pk_bf16_f32 v92, v110, v111
    v_lshlrev_b32 v110, 16, v93
    v_and_b32 v111, 0xffff0000, v93
    v_add_f32 v110, s73, v110
    v_add_f32 v111, s73, v111
    v_cvt_pk_bf16_f32 v93, v110, v111
    v_lshlrev_b32 v110, 16, v94
    v_and_b32 v111, 0xffff0000, v94
    v_add_f32 v110, s73, v110
    v_add_f32 v111, s73, v111
    v_cvt_pk_bf16_f32 v94, v110, v111
    v_lshlrev_b32 v110, 16, v95
    v_and_b32 v111, 0xffff0000, v95
    v_add_f32 v110, s73, v110
    v_add_f32 v111, s73, v111
    v_cvt_pk_bf16_f32 v95, v110, v111
    v_lshlrev_b32 v110, 16, v96
    v_and_b32 v111, 0xffff0000, v96
    v_add_f32 v110, s73, v110
    v_add_f32 v111, s73, v111
    v_cvt_pk_bf16_f32 v96, v110, v111
    v_lshlrev_b32 v110, 16, v97
    v_and_b32 v111, 0xffff0000, v97
    v_add_f32 v110, s73, v110
    v_add_f32 v111, s73, v111
    v_cvt_pk_bf16_f32 v97, v110, v111
    v_lshlrev_b32 v110, 16, v98
    v_and_b32 v111, 0xffff0000, v98
    v_add_f32 v110, s73, v110
    v_add_f32 v111, s73, v111
    v_cvt_pk_bf16_f32 v98, v110, v111
    v_lshlrev_b32 v110, 16, v99
    v_and_b32 v111, 0xffff0000, v99
    v_add_f32 v110, s73, v110
    v_add_f32 v111, s73, v111
    v_cvt_pk_bf16_f32 v99, v110, v111
KB_K_PHF:
    s_nop 1
    v_mfma_f32_32x32x16_bf16 v[132:147], v[92:95], v[100:103], 0
    v_mfma_f32_32x32x16_bf16 v[132:147], v[96:99], v[104:107], v[132:147]
    v_mfma_f32_32x32x16_bf16 v[52:67], v[116:119], v[92:95], 0
    v_mfma_f32_32x32x16_bf16 v[52:67], v[116:119], v[96:99], v[52:67]
    s_lshl_b32 s74, s70, 8
    s_lshl_b32 s75, s71, 7
    s_add_u32 s74, s74, s75
    s_add_u32 s74, s74, 0x6000
    v_lshl_add_u32 v215, v2, 2, s74
    s_lshl_b32 s74, s70, 12
    s_lshl_b32 s75, s71, 11
    s_add_u32 s74, s74, s75
    s_add_u32 s74, s74, 0xc000
    v_lshrrev_b32 v216, 4, v2
    v_lshlrev_b32 v216, 10, v216
    v_lshl_add_u32 v216, v3, 8, v216
    v_lshl_add_u32 v216, v222, 2, v216
    v_add_u32 v216, s74, v216
    v_cndmask_b32 v124, v140, v132, s[100:101]
    v_cndmask_b32 v125, v141, v133, s[100:101]
    v_cndmask_b32 v126, v142, v134, s[100:101]
    v_cndmask_b32 v127, v143, v135, s[100:101]
    v_cndmask_b32 v128, v144, v136, s[100:101]
    v_cndmask_b32 v129, v145, v137, s[100:101]
    v_cndmask_b32 v130, v146, v138, s[100:101]
    v_cndmask_b32 v131, v147, v139, s[100:101]
    ds_write_b32 v216, v124 offset:0
    ds_write_b32 v216, v125 offset:64
    ds_write_b32 v216, v126 offset:128
    ds_write_b32 v216, v127 offset:192
    ds_write_b32 v216, v128 offset:512
    ds_write_b32 v216, v129 offset:576
    ds_write_b32 v216, v130 offset:640
    ds_write_b32 v216, v131 offset:704
    ds_write_b32 v215, v52
    v_cmp_eq_u32 vcc, 0, v220
    s_nop 2
    s_cbranch_vccz KB_NOK
    s_mov_b32 s75, 200000
KB_NRETRY:
    buffer_load_dwordx2 v[220:221], v254, s[20:23], 0 offen sc1
    s_waitcnt vmcnt(0)
    v_cmp_eq_u32 vcc, 0, v220
    s_nop 4
    s_cbranch_vccz KB_NOK
    s_sub_u32 s75, s75, 1
    s_cmp_lg_u32 s75, 0
    s_cbranch_scc1 KB_NRETRY
KB_NOK:
    s_nop 3
    s_waitcnt lgkmcnt(0)
    s_barrier
    s_cmp_ge_u32 s66, 5
    s_cbranch_scc1 KB_P2_S
    s_mul_i32 s74, s68, 69632
    s_add_u32 s74, s74, 0x701000
    v_mul_u32_u24 v227, 4352, v223
    v_lshl_add_u32 v227, v222, 4, v227
    v_add_u32 v227, s74, v227
    s_add_u32 s74, s76, 0xc000
    s_mov_b32 s39, 0x1000
    s_cmp_eq_u32 s66, 4
    s_cselect_b32 s39, 0x100, s39
    s_cselect_b32 s74, 0x6000, s74
    s_cselect_b32 exec_lo, 0xffff, -1
    s_cselect_b32 exec_hi, 0, -1
    v_lshl_add_u32 v217, v1, 4, s74
    ds_read_b128 v[116:119], v217
    v_add_u32 v217, s39, v217
    ds_read_b128 v[120:123], v217
    v_add_u32 v217, s39, v217
    ds_read_b128 v[124:127], v217
    v_add_u32 v217, s39, v217
    ds_read_b128 v[128:131], v217
    s_mul_i32 s74, s68, 69632
    s_add_u32 s74, s74, 0x700000
    v_lshl_add_u32 v226, v0, 4, s74
    s_mul_i32 s75, s67, 4352
    s_mov_b32 s36, 0x03020105
    s_mov_b32 s37, 0x03020106
    s_mov_b32 s38, 0x03020107
    v_mov_b32 v7, v220
    s_waitcnt lgkmcnt(2)
    v_pk_add_f32 v[116:117], v[116:117], v[120:121] op_sel:[0,0] op_sel_hi:[1,1]
    v_pk_add_f32 v[118:119], v[118:119], v[122:123] op_sel:[0,0] op_sel_hi:[1,1]
    s_waitcnt lgkmcnt(0)
    v_pk_add_f32 v[124:125], v[124:125], v[128:129] op_sel:[0,0] op_sel_hi:[1,1]
    v_pk_add_f32 v[126:127], v[126:127], v[130:131] op_sel:[0,0] op_sel_hi:[1,1]
    v_pk_add_f32 v[116:117], v[116:117], v[124:125] op_sel:[0,0] op_sel_hi:[1,1]
    v_pk_add_f32 v[118:119], v[118:119], v[126:127] op_sel:[0,0] op_sel_hi:[1,1]
    v_add_u32 v119, 0x80, v119
    v_perm_b32 v4, v119, v116, s36
    v_perm_b32 v5, v119, v117, s37
    v_perm_b32 v6, v119, v118, s38
    buffer_store_dwordx4 v[4:7], v226, s[16:19], s75 offen sc1
    s_mov_b64 exec, -1
KB_P2E:
KB_P2_D:
    s_nop 1
    s_waitcnt vmcnt(3)
    s_barrier
    ds_read_b128 v[4:7], v233 offset:32768
    ds_read_b64_tr_b16 v[8:9], v247 offset:32768
    ds_read_b64_tr_b16 v[10:11], v247 offset:33280
    ds_read_b128 v[12:15], v234 offset:32768
    ds_read_b64_tr_b16 v[16:17], v247 offset:34816
    ds_read_b64_tr_b16 v[18:19], v247 offset:35328
    ds_read_b128 v[20:23], v235 offset:32768
    ds_read_b64_tr_b16 v[24:25], v247 offset:36864
    ds_read_b64_tr_b16 v[26:27], v247 offset:37376
    ds_read_b128 v[28:31], v236 offset:32768
    ds_read_b64_tr_b16 v[32:33], v247 offset:38912
    ds_read_b64_tr_b16 v[34:35], v247 offset:39424
    s_waitcnt lgkmcnt(9)
    v_mfma_f32_32x32x16_bf16 v[68:83], v[8:11], v[4:7], 0
    s_waitcnt vmcnt(3)
    s_barrier
    ds_read_b128 v[4:7], v237 offset:0
    ds_read_b64_tr_b16 v[8:9], v247 offset:40960
    ds_read_b64_tr_b16 v[10:11], v247 offset:41472
    s_add_u32 m0, s76, 0x6000
    s_mul_i32 s78, s50, 0x10000
    buffer_load_dwordx4 v225, s[28:31], s78 offen lds
    s_waitcnt lgkmcnt(9)
    v_mfma_f32_32x32x16_bf16 v[68:83], v[16:19], v[12:15], v[68:83]
    s_add_u32 m0, s76, 0xc000
    s_mul_i32 s78, s54, 0x10000
    buffer_load_dwordx4 v225, s[28:31], s78 offen lds
    ds_read_b128 v[12:15], v238 offset:0
    ds_read_b64_tr_b16 v[16:17], v247 offset:43008
    ds_read_b64_tr_b16 v[18:19], v247 offset:43520
    s_waitcnt lgkmcnt(9)
    v_mfma_f32_32x32x16_bf16 v[68:83], v[24:27], v[20:23], v[68:83]
    s_add_u32 m0, s76, 0xe000
    s_mul_i32 s78, s55, 0x10000
    buffer_load_dwordx4 v225, s[28:31], s78 offen lds
    ds_read_b128 v[20:23], v239 offset:0
    ds_read_b64_tr_b16 v[24:25], v247 offset:45056
    ds_read_b64_tr_b16 v[26:27], v247 offset:45568
    s_waitcnt lgkmcnt(9)
    v_mfma_f32_32x32x16_bf16 v[68:83], v[32:35], v[28:31], v[68:83]
    ds_read_b128 v[28:31], v240 offset:0
    ds_read_b64_tr_b16 v[32:33], v247 offset:47104
    ds_read_b64_tr_b16 v[34:35], v247 offset:47616
    s_waitcnt lgkmcnt(9)
    v_mfma_f32_32x32x16_bf16 v[68:83], v[8:11], v[4:7], v[68:83]
    s_waitcnt vmcnt(6)
    s_barrier
    ds_read_b128 v[4:7], v229 offset:0
    ds_read_b64_tr_b16 v[8:9], v251 offset:0
    ds_read_b64_tr_b16 v[10:11], v251 offset:512
    s_add_u32 m0, s76, 0x1c000
    s_mul_i32 s78, s60, 0x30000
    buffer_load_dwordx4 v228, s[8:11], s78 offen lds
    s_waitcnt lgkmcnt(9)
    v_mfma_f32_32x32x16_bf16 v[68:83], v[16:19], v[12:15], v[68:83]
    ds_read_b128 v[12:15], v230 offset:0
    ds_read_b64_tr_b16 v[16:17], v251 offset:2048
    ds_read_b64_tr_b16 v[18:19], v251 offset:2560
    s_waitcnt lgkmcnt(9)
    v_mfma_f32_32x32x16_bf16 v[68:83], v[24:27], v[20:23], v[68:83]
    ds_read_b128 v[20:23], v231 offset:0
    ds_read_b64_tr_b16 v[24:25], v251 offset:4096
    ds_read_b64_tr_b16 v[26:27], v251 offset:4608
    s_waitcnt lgkmcnt(9)
    v_mfma_f32_32x32x16_bf16 v[68:83], v[32:35], v[28:31], v[68:83]
    ds_read_b128 v[28:31], v232 offset:0
    ds_read_b64_tr_b16 v[32:33], v251 offset:6144
    ds_read_b64_tr_b16 v[34:35], v251 offset:6656
    s_waitcnt lgkmcnt(9)
    v_mfma_f32_32x32x16_bf16 v[68:83], v[8:11], v[4:7], v[68:83]
    s_waitcnt vmcnt(7)
    s_barrier
    ds_read_b128 v[4:7], v229 offset:32768
    ds_read_b64_tr_b16 v[8:9], v251 offset:8192
    ds_read_b64_tr_b16 v[10:11], v251 offset:8704
    s_waitcnt lgkmcnt(9)
    v_mfma_f32_32x32x16_bf16 v[68:83], v[16:19], v[12:15], v[68:83]
    ds_read_b128 v[12:15], v230 offset:32768
    ds_read_b64_tr_b16 v[16:17], v251 offset:10240
    ds_read_b64_tr_b16 v[18:19], v251 offset:10752
    s_waitcnt lgkmcnt(9)
    v_mfma_f32_32x32x16_bf16 v[68:83], v[24:27], v[20:23], v[68:83]
    ds_read_b128 v[20:23], v231 offset:32768
    ds_read_b64_tr_b16 v[24:25], v251 offset:12288
    ds_read_b64_tr_b16 v[26:27], v251 offset:12800
    s_waitcnt lgkmcnt(9)
    v_mfma_f32_32x32x16_bf16 v[68:83], v[32:35], v[28:31], v[68:83]
    ds_read_b128 v[28:31], v232 offset:32768
    ds_read_b64_tr_b16 v[32:33], v251 offset:14336
    ds_read_b64_tr_b16 v[34:35], v251 offset:14848
    s_waitcnt lgkmcnt(9)
    v_mfma_f32_32x32x16_bf16 v[68:83], v[8:11], v[4:7], v[68:83]
    s_waitcnt vmcnt(7)
    s_barrier
    ds_read_b128 v[4:7], v233 offset:0
    ds_read_b64_tr_b16 v[8:9], v243 offset:0
    ds_read_b64_tr_b16 v[10:11], v243 offset:512
    s_waitcnt lgkmcnt(9)
    v_mfma_f32_32x32x16_bf16 v[68:83], v[16:19], v[12:15], v[68:83]
    ds_read_b128 v[12:15], v234 offset:0
    ds_read_b64_tr_b16 v[16:17], v243 offset:2048
    ds_read_b64_tr_b16 v[18:19], v243 offset:2560
    s_waitcnt lgkmcnt(9)
    v_mfma_f32_32x32x16_bf16 v[68:83], v[24:27], v[20:23], v[68:83]
    ds_read_b128 v[20:23], v235 offset:0
    ds_read_b64_tr_b16 v[24:25], v243 offset:4096
    ds_read_b64_tr_b16 v[26:27], v243 offset:4608
    s_waitcnt lgkmcnt(9)
    v_mfma_f32_32x32x16_bf16 v[68:83], v[32:35], v[28:31], v[68:83]
    ds_read_b128 v[28:31], v236 offset:0
    ds_read_b64_tr_b16 v[32:33], v243 offset:6144
    ds_read_b64_tr_b16 v[34:35], v243 offset:6656
    s_waitcnt lgkmcnt(9)
    v_mfma_f32_32x32x16_bf16 v[68:83], v[8:11], v[4:7], v[68:83]
    s_waitcnt vmcnt(6)
    s_barrier
    ds_read_b64_tr_b16 v[8:9], v247 offset:0
    ds_read_b64_tr_b16 v[10:11], v247 offset:512
    s_add_u32 m0, s76, 0x8000
    s_mul_i32 s78, s52, 0x10000
    buffer_load_dwordx4 v225, s[28:31], s78 offen lds
    s_waitcnt lgkmcnt(8)
    v_mfma_f32_32x32x16_bf16 v[68:83], v[16:19], v[12:15], v[68:83]
    s_add_u32 m0, s76, 0xa000
    s_mul_i32 s78, s53, 0x10000
    buffer_load_dwordx4 v225, s[28:31], s78 offen lds
    ds_read_b64_tr_b16 v[16:17], v247 offset:2048
    ds_read_b64_tr_b16 v[18:19], v247 offset:2560
    s_waitcnt lgkmcnt(7)
    v_mfma_f32_32x32x16_bf16 v[68:83], v[24:27], v[20:23], v[68:83]
    ds_read_b64_tr_b16 v[24:25], v247 offset:4096
    ds_read_b64_tr_b16 v[26:27], v247 offset:4608
    s_waitcnt lgkmcnt(6)
    v_mfma_f32_32x32x16_bf16 v[68:83], v[32:35], v[28:31], v[68:83]
    ds_read_b64_tr_b16 v[32:33], v247 offset:6144
    ds_read_b64_tr_b16 v[34:35], v247 offset:6656
    s_waitcnt lgkmcnt(6)
    v_mfma_f32_32x32x16_bf16 v[68:83], v[8:11], v[148:151], v[68:83]
    s_waitcnt vmcnt(7)
    s_barrier
    ds_read_b64_tr_b16 v[8:9], v247 offset:8192
    ds_read_b64_tr_b16 v[10:11], v247 offset:8704
    s_add_u32 m0, s76, 0x10000
    s_mul_i32 s78, s56, 0x10000
    buffer_load_dwordx4 v225, s[28:31], s78 offen lds
    s_waitcnt lgkmcnt(6)
    v_mfma_f32_32x32x16_bf16 v[68:83], v[16:19], v[152:155], v[68:83]
    s_add_u32 m0, s76, 0x12000
    s_mul_i32 s78, s57, 0x10000
    buffer_load_dwordx4 v225, s[28:31], s78 offen lds
    ds_read_b64_tr_b16 v[16:17], v247 offset:10240
    ds_read_b64_tr_b16 v[18:19], v247 offset:10752
    s_waitcnt lgkmcnt(6)
    v_mfma_f32_32x32x16_bf16 v[68:83], v[24:27], v[156:159], v[68:83]
    s_add_u32 m0, s76, 0x4000
    s_mul_i32 s78, s51, 0x10000
    buffer_load_dwordx4 v225, s[28:31], s78 offen lds
    ds_read_b64_tr_b16 v[24:25], v247 offset:12288
    ds_read_b64_tr_b16 v[26:27], v247 offset:12800
    s_waitcnt lgkmcnt(6)
    v_mfma_f32_32x32x16_bf16 v[68:83], v[32:35], v[160:163], v[68:83]
    ds_read_b64_tr_b16 v[32:33], v247 offset:14336
    ds_read_b64_tr_b16 v[34:35], v247 offset:14848
    s_waitcnt lgkmcnt(6)
    v_mfma_f32_32x32x16_bf16 v[68:83], v[8:11], v[164:167], v[68:83]
    s_waitcnt vmcnt(5)
    s_barrier
    ds_read_b64_tr_b16 v[8:9], v247 offset:32768
    ds_read_b64_tr_b16 v[10:11], v247 offset:33280
    s_cmp_lg_u32 s66, 4
    s_cbranch_scc1 KB_ZLE
    s_mov_b32 s78, 0
    buffer_load_dwordx4 v[84:87], v227, s[16:19], s78 offen sc1
    s_mov_b32 s78, 17408
    buffer_load_dwordx4 v[88:91], v227, s[16:19], s78 offen sc1
    s_mov_b32 s78, 34816
    buffer_load_dwordx4 v[92:95], v227, s[16:19], s78 offen sc1
    s_mov_b32 s78, 52224
    buffer_load_dwordx4 v[96:99], v227, s[16:19], s78 offen sc1
KB_ZLE:
    s_nop 1
    s_waitcnt lgkmcnt(6)
    v_mfma_f32_32x32x16_bf16 v[68:83], v[16:19], v[168:171], v[68:83]
    ds_read_b64_tr_b16 v[16:17], v247 offset:34816
    ds_read_b64_tr_b16 v[18:19], v247 offset:35328
    s_waitcnt lgkmcnt(6)
    v_mfma_f32_32x32x16_bf16 v[68:83], v[24:27], v[172:175], v[68:83]
    ds_read_b64_tr_b16 v[24:25], v247 offset:36864
    ds_read_b64_tr_b16 v[26:27], v247 offset:37376
    s_waitcnt lgkmcnt(6)
    v_mfma_f32_32x32x16_bf16 v[68:83], v[32:35], v[176:179], v[68:83]
    ds_read_b64_tr_b16 v[32:33], v247 offset:38912
    ds_read_b64_tr_b16 v[34:35], v247 offset:39424
    s_waitcnt lgkmcnt(6)
    v_mfma_f32_32x32x16_bf16 v[68:83], v[8:11], v[180:183], v[68:83]
    s_barrier
    s_cmp_ge_u32 s66, 4
    s_cbranch_scc1 KB_PC0
    s_mov_b32 s78, 0
    buffer_load_dwordx4 v[84:87], v226, s[16:19], s78 offen sc1
    s_mov_b32 s78, 4352
    buffer_load_dwordx4 v[88:91], v226, s[16:19], s78 offen sc1
KB_PC0:
    s_cmp_ge_u32 s66, 4
    s_cbranch_scc1 KB_PC2
    s_mov_b32 s78, 8704
    buffer_load_dwordx4 v[92:95], v226, s[16:19], s78 offen sc1
    s_mov_b32 s78, 13056
    buffer_load_dwordx4 v[96:99], v226, s[16:19], s78 offen sc1
KB_PC2:
    s_waitcnt lgkmcnt(4)
    v_mfma_f32_32x32x16_bf16 v[68:83], v[16:19], v[184:187], v[68:83]
    s_cmp_ge_u32 s66, 4
    s_cbranch_scc1 KB_PC4
    s_mov_b32 s78, 17408
    buffer_load_dwordx4 v[100:103], v226, s[16:19], s78 offen sc1
    s_mov_b32 s78, 21760
    buffer_load_dwordx4 v[104:107], v226, s[16:19], s78 offen sc1
KB_PC4:
    s_waitcnt lgkmcnt(2)
    v_mfma_f32_32x32x16_bf16 v[68:83], v[24:27], v[188:191], v[68:83]
    s_cmp_ge_u32 s66, 4
    s_cbranch_scc1 KB_PC6
    s_mov_b32 s78, 26112
    buffer_load_dwordx4 v[108:111], v226, s[16:19], s78 offen sc1
    s_mov_b32 s78, 30464
    buffer_load_dwordx4 v[112:115], v226, s[16:19], s78 offen sc1
KB_PC6:
    s_waitcnt lgkmcnt(0)
    v_mfma_f32_32x32x16_bf16 v[68:83], v[32:35], v[192:195], v[68:83]
    s_cmp_ge_u32 s66, 4
    s_cbranch_scc1 KB_PC8
    s_mov_b32 s78, 34816
    buffer_load_dwordx4 v[116:119], v226, s[16:19], s78 offen sc1
    s_mov_b32 s78, 39168
    buffer_load_dwordx4 v[120:123], v226, s[16:19], s78 offen sc1
KB_PC8:
    s_cmp_ge_u32 s66, 4
    s_cbranch_scc1 KB_PC10
    s_mov_b32 s78, 43520
    buffer_load_dwordx4 v[124:127], v226, s[16:19], s78 offen sc1
    s_mov_b32 s78, 47872
    buffer_load_dwordx4 v[128:131], v226, s[16:19], s78 offen sc1
KB_PC10:
    s_cmp_ge_u32 s66, 4
    s_cbranch_scc1 KB_PC12
    s_mov_b32 s78, 52224
    buffer_load_dwordx4 v[132:135], v226, s[16:19], s78 offen sc1
    s_mov_b32 s78, 56576
    buffer_load_dwordx4 v[136:139], v226, s[16:19], s78 offen sc1
KB_PC12:
    s_cmp_ge_u32 s66, 4
    s_cbranch_scc1 KB_PC14
    s_mov_b32 s78, 60928
    buffer_load_dwordx4 v[140:143], v226, s[16:19], s78 offen sc1
    s_mov_b32 s78, 65280
    buffer_load_dwordx4 v[144:147], v226, s[16:19], s78 offen sc1
KB_PC14:
    s_nop 11
    s_mov_b32 s72, 0x3fb8aa3b
    s_mov_b32 s73, 0x358637bd
    s_mov_b32 s80, 0x3fb8aa3b
    s_mov_b32 s81, 1.0
    v_cvt_pk_bf16_f32 v189, v68, v69
    v_lshlrev_b32 v188, 16, v189
    v_and_b32 v189, 0xffff0000, v189
    v_pk_mul_f32 v[190:191], s[80:81], v[188:189] op_sel_hi:[0,1]
    v_exp_f32 v190, v190 clamp
    v_exp_f32 v191, v191 clamp
    v_pk_add_f32 v[188:189], s[80:81], v[188:189] op_sel:[1,0] op_sel_hi:[1,1]
    v_max_f32 v190, v190, v188
    v_max_f32 v191, v191, v189
    v_cvt_pk_bf16_f32 v180, v190, v191
    v_min_f32 v192, v190, v191
    v_cvt_pk_bf16_f32 v189, v70, v71
    v_lshlrev_b32 v188, 16, v189
    v_and_b32 v189, 0xffff0000, v189
    v_pk_mul_f32 v[190:191], s[80:81], v[188:189] op_sel_hi:[0,1]
    v_exp_f32 v190, v190 clamp
    v_exp_f32 v191, v191 clamp
    v_pk_add_f32 v[188:189], s[80:81], v[188:189] op_sel:[1,0] op_sel_hi:[1,1]
    v_max_f32 v190, v190, v188
    v_max_f32 v191, v191, v189
    v_cvt_pk_bf16_f32 v181, v190, v191
    v_min3_f32 v192, v190, v191, v192
    v_cvt_pk_bf16_f32 v189, v72, v73
    v_lshlrev_b32 v188, 16, v189
    v_and_b32 v189, 0xffff0000, v189
    v_pk_mul_f32 v[190:191], s[80:81], v[188:189] op_sel_hi:[0,1]
    v_exp_f32 v190, v190 clamp
    v_exp_f32 v191, v191 clamp
    v_pk_add_f32 v[188:189], s[80:81], v[188:189] op_sel:[1,0] op_sel_hi:[1,1]
    v_max_f32 v190, v190, v188
    v_max_f32 v191, v191, v189
    v_cvt_pk_bf16_f32 v182, v190, v191
    v_min3_f32 v192, v190, v191, v192
    v_cvt_pk_bf16_f32 v189, v74, v75
    v_lshlrev_b32 v188, 16, v189
    v_and_b32 v189, 0xffff0000, v189
    v_pk_mul_f32 v[190:191], s[80:81], v[188:189] op_sel_hi:[0,1]
    v_exp_f32 v190, v190 clamp
    v_exp_f32 v191, v191 clamp
    v_pk_add_f32 v[188:189], s[80:81], v[188:189] op_sel:[1,0] op_sel_hi:[1,1]
    v_max_f32 v190, v190, v188
    v_max_f32 v191, v191, v189
    v_cvt_pk_bf16_f32 v183, v190, v191
    v_min3_f32 v192, v190, v191, v192
    v_cvt_pk_bf16_f32 v189, v76, v77
    v_lshlrev_b32 v188, 16, v189
    v_and_b32 v189, 0xffff0000, v189
    v_pk_mul_f32 v[190:191], s[80:81], v[188:189] op_sel_hi:[0,1]
    v_exp_f32 v190, v190 clamp
    v_exp_f32 v191, v191 clamp
    v_pk_add_f32 v[188:189], s[80:81], v[188:189] op_sel:[1,0] op_sel_hi:[1,1]
    v_max_f32 v190, v190, v188
    v_max_f32 v191, v191, v189
    v_cvt_pk_bf16_f32 v184, v190, v191
    v_min3_f32 v192, v190, v191, v192
    v_cvt_pk_bf16_f32 v189, v78, v79
    v_lshlrev_b32 v188, 16, v189
    v_and_b32 v189, 0xffff0000, v189
    v_pk_mul_f32 v[190:191], s[80:81], v[188:189] op_sel_hi:[0,1]
    v_exp_f32 v190, v190 clamp
    v_exp_f32 v191, v191 clamp
    v_pk_add_f32 v[188:189], s[80:81], v[188:189] op_sel:[1,0] op_sel_hi:[1,1]
    v_max_f32 v190, v190, v188
    v_max_f32 v191, v191, v189
    v_cvt_pk_bf16_f32 v185, v190, v191
    v_min3_f32 v192, v190, v191, v192
    v_cvt_pk_bf16_f32 v189, v80, v81
    v_lshlrev_b32 v188, 16, v189
    v_and_b32 v189, 0xffff0000, v189
    v_pk_mul_f32 v[190:191], s[80:81], v[188:189] op_sel_hi:[0,1]
    v_exp_f32 v190, v190 clamp
    v_exp_f32 v191, v191 clamp
    v_pk_add_f32 v[188:189], s[80:81], v[188:189] op_sel:[1,0] op_sel_hi:[1,1]
    v_max_f32 v190, v190, v188
    v_max_f32 v191, v191, v189
    v_cvt_pk_bf16_f32 v186, v190, v191
    v_min3_f32 v192, v190, v191, v192
    v_cvt_pk_bf16_f32 v189, v82, v83
    v_lshlrev_b32 v188, 16, v189
    v_and_b32 v189, 0xffff0000, v189
    v_pk_mul_f32 v[190:191], s[80:81], v[188:189] op_sel_hi:[0,1]
    v_exp_f32 v190, v190 clamp
    v_exp_f32 v191, v191 clamp
    v_pk_add_f32 v[188:189], s[80:81], v[188:189] op_sel:[1,0] op_sel_hi:[1,1]
    v_max_f32 v190, v190, v188
    v_max_f32 v191, v191, v189
    v_cvt_pk_bf16_f32 v187, v190, v191
    v_min3_f32 v192, v190, v191, v192
    v_cmp_gt_f32 vcc, 0x3a800000, v192
    s_nop 2
    s_cbranch_vccz KB_Q_PHF
    v_lshlrev_b32 v188, 16, v180
    v_and_b32 v189, 0xffff0000, v180
    v_add_f32 v188, s73, v188
    v_add_f32 v189, s73, v189
    v_cvt_pk_bf16_f32 v180, v188, v189
    v_lshlrev_b32 v188, 16, v181
    v_and_b32 v189, 0xffff0000, v181
    v_add_f32 v188, s73, v188
    v_add_f32 v189, s73, v189
    v_cvt_pk_bf16_f32 v181, v188, v189
    v_lshlrev_b32 v188, 16, v182
    v_and_b32 v189, 0xffff0000, v182
    v_add_f32 v188, s73, v188
    v_add_f32 v189, s73, v189
    v_cvt_pk_bf16_f32 v182, v188, v189
    v_lshlrev_b32 v188, 16, v183
    v_and_b32 v189, 0xffff0000, v183
    v_add_f32 v188, s73, v188
    v_add_f32 v189, s73, v189
    v_cvt_pk_bf16_f32 v183, v188, v189
    v_lshlrev_b32 v188, 16, v184
    v_and_b32 v189, 0xffff0000, v184
    v_add_f32 v188, s73, v188
    v_add_f32 v189, s73, v189
    v_cvt_pk_bf16_f32 v184, v188, v189
    v_lshlrev_b32 v188, 16, v185
    v_and_b32 v189, 0xffff0000, v185
    v_add_f32 v188, s73, v188
    v_add_f32 v189, s73, v189
    v_cvt_pk_bf16_f32 v185, v188, v189
    v_lshlrev_b32 v188, 16, v186
    v_and_b32 v189, 0xffff0000, v186
    v_add_f32 v188, s73, v188
    v_add_f32 v189, s73, v189
    v_cvt_pk_bf16_f32 v186, v188, v189
    v_lshlrev_b32 v188, 16, v187
    v_and_b32 v189, 0xffff0000, v187
    v_add_f32 v188, s73, v188
    v_add_f32 v189, s73, v189
    v_cvt_pk_bf16_f32 v187, v188, v189
KB_Q_PHF:
    s_nop 1
    s_mov_b32 s36, 0x0c04000c
    s_cmp_ge_u32 s66, 5
    s_cbranch_scc1 KB_KVE
    s_cmp_eq_u32 s66, 4
    s_cbranch_scc1 KB_KVZ
    v_lshrrev_b32 v36, 6, v0
    v_lshlrev_b32 v36, 10, v36
    v_bfe_u32 v215, v0, 2, 2
    v_lshl_add_u32 v36, v215, 1, v36
    v_bfe_u32 v215, v0, 5, 1
    v_lshl_add_u32 v36, v215, 3, v36
    v_bfe_u32 v215, v0, 4, 1
    v_lshl_add_u32 v36, v215, 4, v36
    v_bfe_u32 v215, v0, 1, 1
    v_lshl_add_u32 v36, v215, 7, v36
    v_bfe_u32 v215, v0, 0, 1
    v_lshl_add_u32 v36, v215, 8, v36
    v_add_u32 v36, 0x1c000, v36
    s_mov_b32 s75, 200000
    s_waitcnt vmcnt(15)
    v_xor_b32 v214, v87, v220
    v_perm_b32 v216, v85, v84, s36
    v_lshl_or_b32 v216, v86, 24, v216
    s_waitcnt vmcnt(14)
    v_xor_b32 v218, v91, v220
    v_perm_b32 v217, v89, v88, s36
    v_lshl_or_b32 v217, v90, 24, v217
    v_pk_add_f32 v[12:13], v[84:85], v[88:89] op_sel:[0,0] op_sel_hi:[1,1]
    v_add_f32 v14, v86, v90
    v_add_f32 v15, v216, v217
    s_waitcnt vmcnt(13)
    v_xor_b32 v215, v95, v220
    v_or3_b32 v214, v214, v218, v215
    v_perm_b32 v216, v93, v92, s36
    v_lshl_or_b32 v216, v94, 24, v216
    v_pk_add_f32 v[12:13], v[12:13], v[92:93] op_sel:[0,0] op_sel_hi:[1,1]
    v_add_f32 v14, v14, v94
    v_add_f32 v15, v15, v216
    s_waitcnt vmcnt(12)
    v_xor_b32 v218, v99, v220
    v_perm_b32 v217, v97, v96, s36
    v_lshl_or_b32 v217, v98, 24, v217
    v_pk_add_f32 v[12:13], v[12:13], v[96:97] op_sel:[0,0] op_sel_hi:[1,1]
    v_add_f32 v14, v14, v98
    v_add_f32 v15, v15, v217
    s_waitcnt vmcnt(11)
    v_xor_b32 v215, v103, v220
    v_or3_b32 v214, v214, v218, v215
    v_perm_b32 v216, v101, v100, s36
    v_lshl_or_b32 v216, v102, 24, v216
    v_pk_add_f32 v[12:13], v[12:13], v[100:101] op_sel:[0,0] op_sel_hi:[1,1]
    v_add_f32 v14, v14, v102
    v_add_f32 v15, v15, v216
    s_waitcnt vmcnt(10)
    v_xor_b32 v218, v107, v220
    v_perm_b32 v217, v105, v104, s36
    v_lshl_or_b32 v217, v106, 24, v217
    v_pk_add_f32 v[12:13], v[12:13], v[104:105] op_sel:[0,0] op_sel_hi:[1,1]
    v_add_f32 v14, v14, v106
    v_add_f32 v15, v15, v217
    s_waitcnt vmcnt(9)
    v_xor_b32 v215, v111, v220
    v_or3_b32 v214, v214, v218, v215
    v_perm_b32 v216, v109, v108, s36
    v_lshl_or_b32 v216, v110, 24, v216
    v_pk_add_f32 v[12:13], v[12:13], v[108:109] op_sel:[0,0] op_sel_hi:[1,1]
    v_add_f32 v14, v14, v110
    v_add_f32 v15, v15, v216
    s_waitcnt vmcnt(8)
    v_xor_b32 v218, v115, v220
    v_perm_b32 v217, v113, v112, s36
    v_lshl_or_b32 v217, v114, 24, v217
    v_pk_add_f32 v[12:13], v[12:13], v[112:113] op_sel:[0,0] op_sel_hi:[1,1]
    v_add_f32 v14, v14, v114
    v_add_f32 v15, v15, v217
    s_waitcnt vmcnt(7)
    v_xor_b32 v215, v119, v220
    v_or3_b32 v214, v214, v218, v215
    v_perm_b32 v216, v117, v116, s36
    v_lshl_or_b32 v216, v118, 24, v216
    v_pk_add_f32 v[12:13], v[12:13], v[116:117] op_sel:[0,0] op_sel_hi:[1,1]
    v_add_f32 v14, v14, v118
    v_add_f32 v15, v15, v216
    s_waitcnt vmcnt(6)
    v_xor_b32 v218, v123, v220
    v_perm_b32 v217, v121, v120, s36
    v_lshl_or_b32 v217, v122, 24, v217
    v_pk_add_f32 v[12:13], v[12:13], v[120:121] op_sel:[0,0] op_sel_hi:[1,1]
    v_add_f32 v14, v14, v122
    v_add_f32 v15, v15, v217
    s_waitcnt vmcnt(5)
    v_xor_b32 v215, v127, v220
    v_or3_b32 v214, v214, v218, v215
    v_perm_b32 v216, v125, v124, s36
    v_lshl_or_b32 v216, v126, 24, v216
    v_pk_add_f32 v[12:13], v[12:13], v[124:125] op_sel:[0,0] op_sel_hi:[1,1]
    v_add_f32 v14, v14, v126
    v_add_f32 v15, v15, v216
    s_waitcnt vmcnt(4)
    v_xor_b32 v218, v131, v220
    v_perm_b32 v217, v129, v128, s36
    v_lshl_or_b32 v217, v130, 24, v217
    v_pk_add_f32 v[12:13], v[12:13], v[128:129] op_sel:[0,0] op_sel_hi:[1,1]
    v_add_f32 v14, v14, v130
    v_add_f32 v15, v15, v217
    s_waitcnt vmcnt(3)
    v_xor_b32 v215, v135, v220
    v_or3_b32 v214, v214, v218, v215
    v_perm_b32 v216, v133, v132, s36
    v_lshl_or_b32 v216, v134, 24, v216
    v_pk_add_f32 v[12:13], v[12:13], v[132:133] op_sel:[0,0] op_sel_hi:[1,1]
    v_add_f32 v14, v14, v134
    v_add_f32 v15, v15, v216
    s_waitcnt vmcnt(2)
    v_xor_b32 v218, v139, v220
    v_perm_b32 v217, v137, v136, s36
    v_lshl_or_b32 v217, v138, 24, v217
    v_pk_add_f32 v[12:13], v[12:13], v[136:137] op_sel:[0,0] op_sel_hi:[1,1]
    v_add_f32 v14, v14, v138
    v_add_f32 v15, v15, v217
    s_waitcnt vmcnt(1)
    v_xor_b32 v215, v143, v220
    v_or3_b32 v214, v214, v218, v215
    v_perm_b32 v216, v141, v140, s36
    v_lshl_or_b32 v216, v142, 24, v216
    v_pk_add_f32 v[12:13], v[12:13], v[140:141] op_sel:[0,0] op_sel_hi:[1,1]
    v_add_f32 v14, v14, v142
    v_add_f32 v15, v15, v216
    s_waitcnt vmcnt(0)
    v_xor_b32 v218, v147, v220
    v_perm_b32 v217, v145, v144, s36
    v_lshl_or_b32 v217, v146, 24, v217
    v_pk_add_f32 v[12:13], v[12:13], v[144:145] op_sel:[0,0] op_sel_hi:[1,1]
    v_add_f32 v14, v14, v146
    v_add_f32 v15, v15, v217
    v_or_b32 v214, v214, v218
    v_cmp_ne_u32 vcc, 0, v214
    s_nop 2
    s_cbranch_vccz KB_KV_SUM
KB_KV_P:
    v_cmp_ne_u32 vcc, v220, v87
    s_nop 2
    s_cbranch_vccz KB_KV_S0
    s_mov_b32 s78, 0
    buffer_load_dwordx4 v[84:87], v226, s[16:19], s78 offen sc1
KB_KV_S0:
    v_cmp_ne_u32 vcc, v220, v91
    s_nop 2
    s_cbranch_vccz KB_KV_S1
    s_mov_b32 s78, 4352
    buffer_load_dwordx4 v[88:91], v226, s[16:19], s78 offen sc1
KB_KV_S1:
    v_cmp_ne_u32 vcc, v220, v95
    s_nop 2
    s_cbranch_vccz KB_KV_S2
    s_mov_b32 s78, 8704
    buffer_load_dwordx4 v[92:95], v226, s[16:19], s78 offen sc1
KB_KV_S2:
    v_cmp_ne_u32 vcc, v220, v99
    s_nop 2
    s_cbranch_vccz KB_KV_S3
    s_mov_b32 s78, 13056
    buffer_load_dwordx4 v[96:99], v226, s[16:19], s78 offen sc1
KB_KV_S3:
    v_cmp_ne_u32 vcc, v220, v103
    s_nop 2
    s_cbranch_vccz KB_KV_S4
    s_mov_b32 s78, 17408
    buffer_load_dwordx4 v[100:103], v226, s[16:19], s78 offen sc1
KB_KV_S4:
    v_cmp_ne_u32 vcc, v220, v107
    s_nop 2
    s_cbranch_vccz KB_KV_S5
    s_mov_b32 s78, 21760
    buffer_load_dwordx4 v[104:107], v226, s[16:19], s78 offen sc1
KB_KV_S5:
    v_cmp_ne_u32 vcc, v220, v111
    s_nop 2
    s_cbranch_vccz KB_KV_S6
    s_mov_b32 s78, 26112
    buffer_load_dwordx4 v[108:111], v226, s[16:19], s78 offen sc1
KB_KV_S6:
    v_cmp_ne_u32 vcc, v220, v115
    s_nop 2
    s_cbranch_vccz KB_KV_S7
    s_mov_b32 s78, 30464
    buffer_load_dwordx4 v[112:115], v226, s[16:19], s78 offen sc1
KB_KV_S7:
    v_cmp_ne_u32 vcc, v220, v119
    s_nop 2
    s_cbranch_vccz KB_KV_S8
    s_mov_b32 s78, 34816
    buffer_load_dwordx4 v[116:119], v226, s[16:19], s78 offen sc1
KB_KV_S8:
    v_cmp_ne_u32 vcc, v220, v123
    s_nop 2
    s_cbranch_vccz KB_KV_S9
    s_mov_b32 s78, 39168
    buffer_load_dwordx4 v[120:123], v226, s[16:19], s78 offen sc1
KB_KV_S9:
    v_cmp_ne_u32 vcc, v220, v127
    s_nop 2
    s_cbranch_vccz KB_KV_S10
    s_mov_b32 s78, 43520
    buffer_load_dwordx4 v[124:127], v226, s[16:19], s78 offen sc1
KB_KV_S10:
    v_cmp_ne_u32 vcc, v220, v131
    s_nop 2
    s_cbranch_vccz KB_KV_S11
    s_mov_b32 s78, 47872
    buffer_load_dwordx4 v[128:131], v226, s[16:19], s78 offen sc1
KB_KV_S11:
    v_cmp_ne_u32 vcc, v220, v135
    s_nop 2
    s_cbranch_vccz KB_KV_S12
    s_mov_b32 s78, 52224
    buffer_load_dwordx4 v[132:135], v226, s[16:19], s78 offen sc1
KB_KV_S12:
    v_cmp_ne_u32 vcc, v220, v139
    s_nop 2
    s_cbranch_vccz KB_KV_S13
    s_mov_b32 s78, 56576
    buffer_load_dwordx4 v[136:139], v226, s[16:19], s78 offen sc1
KB_KV_S13:
    v_cmp_ne_u32 vcc, v220, v143
    s_nop 2
    s_cbranch_vccz KB_KV_S14
    s_mov_b32 s78, 60928
    buffer_load_dwordx4 v[140:143], v226, s[16:19], s78 offen sc1
KB_KV_S14:
    v_cmp_ne_u32 vcc, v220, v147
    s_nop 2
    s_cbranch_vccz KB_KV_S15
    s_mov_b32 s78, 65280
    buffer_load_dwordx4 v[144:147], v226, s[16:19], s78 offen sc1
KB_KV_S15:
    s_waitcnt vmcnt(0)
KB_KV_CHK2:
    v_mov_b32 v214, 0
    v_xor_b32 v218, v87, v220
    v_xor_b32 v215, v91, v220
    v_or3_b32 v214, v214, v218, v215
    v_xor_b32 v218, v95, v220
    v_xor_b32 v215, v99, v220
    v_or3_b32 v214, v214, v218, v215
    v_xor_b32 v218, v103, v220
    v_xor_b32 v215, v107, v220
    v_or3_b32 v214, v214, v218, v215
    v_xor_b32 v218, v111, v220
    v_xor_b32 v215, v115, v220
    v_or3_b32 v214, v214, v218, v215
    v_xor_b32 v218, v119, v220
    v_xor_b32 v215, v123, v220
    v_or3_b32 v214, v214, v218, v215
    v_xor_b32 v218, v127, v220
    v_xor_b32 v215, v131, v220
    v_or3_b32 v214, v214, v218, v215
    v_xor_b32 v218, v135, v220
    v_xor_b32 v215, v139, v220
    v_or3_b32 v214, v214, v218, v215
    v_xor_b32 v218, v143, v220
    v_xor_b32 v215, v147, v220
    v_or3_b32 v214, v214, v218, v215
    v_cmp_ne_u32 vcc, 0, v214
    s_nop 2
    s_cbranch_vccz KB_KV_OK
    s_sleep 1
    s_sub_u32 s75, s75, 1
    s_cmp_lg_u32 s75, 0
    s_cbranch_scc1 KB_KV_P
KB_KV_OK:
    s_nop 3
    v_perm_b32 v87, v85, v84, s36
    v_lshl_or_b32 v87, v86, 24, v87
    v_perm_b32 v91, v89, v88, s36
    v_lshl_or_b32 v91, v90, 24, v91
    v_pk_add_f32 v[12:13], v[84:85], v[88:89] op_sel:[0,0] op_sel_hi:[1,1]
    v_pk_add_f32 v[14:15], v[86:87], v[90:91] op_sel:[0,0] op_sel_hi:[1,1]
    v_perm_b32 v95, v93, v92, s36
    v_lshl_or_b32 v95, v94, 24, v95
    v_pk_add_f32 v[12:13], v[12:13], v[92:93] op_sel:[0,0] op_sel_hi:[1,1]
    v_pk_add_f32 v[14:15], v[14:15], v[94:95] op_sel:[0,0] op_sel_hi:[1,1]
    v_perm_b32 v99, v97, v96, s36
    v_lshl_or_b32 v99, v98, 24, v99
    v_pk_add_f32 v[12:13], v[12:13], v[96:97] op_sel:[0,0] op_sel_hi:[1,1]
    v_pk_add_f32 v[14:15], v[14:15], v[98:99] op_sel:[0,0] op_sel_hi:[1,1]
    v_perm_b32 v103, v101, v100, s36
    v_lshl_or_b32 v103, v102, 24, v103
    v_pk_add_f32 v[12:13], v[12:13], v[100:101] op_sel:[0,0] op_sel_hi:[1,1]
    v_pk_add_f32 v[14:15], v[14:15], v[102:103] op_sel:[0,0] op_sel_hi:[1,1]
    v_perm_b32 v107, v105, v104, s36
    v_lshl_or_b32 v107, v106, 24, v107
    v_pk_add_f32 v[12:13], v[12:13], v[104:105] op_sel:[0,0] op_sel_hi:[1,1]
    v_pk_add_f32 v[14:15], v[14:15], v[106:107] op_sel:[0,0] op_sel_hi:[1,1]
    v_perm_b32 v111, v109, v108, s36
    v_lshl_or_b32 v111, v110, 24, v111
    v_pk_add_f32 v[12:13], v[12:13], v[108:109] op_sel:[0,0] op_sel_hi:[1,1]
    v_pk_add_f32 v[14:15], v[14:15], v[110:111] op_sel:[0,0] op_sel_hi:[1,1]
    v_perm_b32 v115, v113, v112, s36
    v_lshl_or_b32 v115, v114, 24, v115
    v_pk_add_f32 v[12:13], v[12:13], v[112:113] op_sel:[0,0] op_sel_hi:[1,1]
    v_pk_add_f32 v[14:15], v[14:15], v[114:115] op_sel:[0,0] op_sel_hi:[1,1]
    v_perm_b32 v119, v117, v116, s36
    v_lshl_or_b32 v119, v118, 24, v119
    v_pk_add_f32 v[12:13], v[12:13], v[116:117] op_sel:[0,0] op_sel_hi:[1,1]
    v_pk_add_f32 v[14:15], v[14:15], v[118:119] op_sel:[0,0] op_sel_hi:[1,1]
    v_perm_b32 v123, v121, v120, s36
    v_lshl_or_b32 v123, v122, 24, v123
    v_pk_add_f32 v[12:13], v[12:13], v[120:121] op_sel:[0,0] op_sel_hi:[1,1]
    v_pk_add_f32 v[14:15], v[14:15], v[122:123] op_sel:[0,0] op_sel_hi:[1,1]
    v_perm_b32 v127, v125, v124, s36
    v_lshl_or_b32 v127, v126, 24, v127
    v_pk_add_f32 v[12:13], v[12:13], v[124:125] op_sel:[0,0] op_sel_hi:[1,1]
    v_pk_add_f32 v[14:15], v[14:15], v[126:127] op_sel:[0,0] op_sel_hi:[1,1]
    v_perm_b32 v131, v129, v128, s36
    v_lshl_or_b32 v131, v130, 24, v131
    v_pk_add_f32 v[12:13], v[12:13], v[128:129] op_sel:[0,0] op_sel_hi:[1,1]
    v_pk_add_f32 v[14:15], v[14:15], v[130:131] op_sel:[0,0] op_sel_hi:[1,1]
    v_perm_b32 v135, v133, v132, s36
    v_lshl_or_b32 v135, v134, 24, v135
    v_pk_add_f32 v[12:13], v[12:13], v[132:133] op_sel:[0,0] op_sel_hi:[1,1]
    v_pk_add_f32 v[14:15], v[14:15], v[134:135] op_sel:[0,0] op_sel_hi:[1,1]
    v_perm_b32 v139, v137, v136, s36
    v_lshl_or_b32 v139, v138, 24, v139
    v_pk_add_f32 v[12:13], v[12:13], v[136:137] op_sel:[0,0] op_sel_hi:[1,1]
    v_pk_add_f32 v[14:15], v[14:15], v[138:139] op_sel:[0,0] op_sel_hi:[1,1]
    v_perm_b32 v143, v141, v140, s36
    v_lshl_or_b32 v143, v142, 24, v143
    v_pk_add_f32 v[12:13], v[12:13], v[140:141] op_sel:[0,0] op_sel_hi:[1,1]
    v_pk_add_f32 v[14:15], v[14:15], v[142:143] op_sel:[0,0] op_sel_hi:[1,1]
    v_perm_b32 v147, v145, v144, s36
    v_lshl_or_b32 v147, v146, 24, v147
    v_pk_add_f32 v[12:13], v[12:13], v[144:145] op_sel:[0,0] op_sel_hi:[1,1]
    v_pk_add_f32 v[14:15], v[14:15], v[146:147] op_sel:[0,0] op_sel_hi:[1,1]
KB_KV_SUM:
    s_nop 1
    v_cvt_pk_bf16_f32 v12, v12, v13
    v_cvt_pk_bf16_f32 v13, v14, v15
    ds_write_b16 v36, v12
    ds_write_b16_d16_hi v36, v12 offset:32
    ds_write_b16 v36, v13 offset:64
    ds_write_b16_d16_hi v36, v13 offset:96
    s_branch KB_KVE
KB_KVZ:
    s_nop 1
    v_bfe_u32 v37, v0, 2, 2
    v_lshlrev_b32 v37, 10, v37
    v_bfe_u32 v215, v0, 1, 1
    v_lshl_add_u32 v37, v215, 3, v37
    v_bfe_u32 v215, v0, 0, 1
    v_lshl_add_u32 v37, v215, 4, v37
    v_add_u32 v37, 0x1c200, v37
    s_mov_b32 s75, 200000
    s_waitcnt vmcnt(0)
    s_branch KB_KZ_CHK2
KB_KZ_P:
    v_cmp_ne_u32 vcc, v220, v87
    s_nop 2
    s_cbranch_vccz KB_KZ_S0
    s_mov_b32 s78, 0
    buffer_load_dwordx4 v[84:87], v227, s[16:19], s78 offen sc1
KB_KZ_S0:
    v_cmp_ne_u32 vcc, v220, v91
    s_nop 2
    s_cbranch_vccz KB_KZ_S1
    s_mov_b32 s78, 17408
    buffer_load_dwordx4 v[88:91], v227, s[16:19], s78 offen sc1
KB_KZ_S1:
    v_cmp_ne_u32 vcc, v220, v95
    s_nop 2
    s_cbranch_vccz KB_KZ_S2
    s_mov_b32 s78, 34816
    buffer_load_dwordx4 v[92:95], v227, s[16:19], s78 offen sc1
KB_KZ_S2:
    v_cmp_ne_u32 vcc, v220, v99
    s_nop 2
    s_cbranch_vccz KB_KZ_S3
    s_mov_b32 s78, 52224
    buffer_load_dwordx4 v[96:99], v227, s[16:19], s78 offen sc1
KB_KZ_S3:
    s_waitcnt vmcnt(0)
KB_KZ_CHK2:
    v_mov_b32 v214, 0
    v_xor_b32 v218, v87, v220
    v_xor_b32 v215, v91, v220
    v_or3_b32 v214, v214, v218, v215
    v_xor_b32 v218, v95, v220
    v_xor_b32 v215, v99, v220
    v_or3_b32 v214, v214, v218, v215
    v_cmp_ne_u32 vcc, 0, v214
    s_nop 2
    s_cbranch_vccz KB_KZ_OK
    s_sleep 1
    s_sub_u32 s75, s75, 1
    s_cmp_lg_u32 s75, 0
    s_cbranch_scc1 KB_KZ_P
KB_KZ_OK:
    s_nop 3
    v_perm_b32 v87, v85, v84, s36
    v_lshl_or_b32 v87, v86, 24, v87
    v_perm_b32 v91, v89, v88, s36
    v_lshl_or_b32 v91, v90, 24, v91
    v_pk_add_f32 v[12:13], v[84:85], v[88:89] op_sel:[0,0] op_sel_hi:[1,1]
    v_pk_add_f32 v[14:15], v[86:87], v[90:91] op_sel:[0,0] op_sel_hi:[1,1]
    v_perm_b32 v95, v93, v92, s36
    v_lshl_or_b32 v95, v94, 24, v95
    v_pk_add_f32 v[12:13], v[12:13], v[92:93] op_sel:[0,0] op_sel_hi:[1,1]
    v_pk_add_f32 v[14:15], v[14:15], v[94:95] op_sel:[0,0] op_sel_hi:[1,1]
    v_perm_b32 v99, v97, v96, s36
    v_lshl_or_b32 v99, v98, 24, v99
    v_pk_add_f32 v[12:13], v[12:13], v[96:97] op_sel:[0,0] op_sel_hi:[1,1]
    v_pk_add_f32 v[14:15], v[14:15], v[98:99] op_sel:[0,0] op_sel_hi:[1,1]
    v_mov_b32 v84, v12
    v_mov_b32 v85, v13
    v_mov_b32 v86, v14
    v_mov_b32 v87, v15
    v_permlane32_swap_b32 v12, v84
    v_permlane32_swap_b32 v13, v85
    v_permlane32_swap_b32 v14, v86
    v_permlane32_swap_b32 v15, v87
    v_pk_add_f32 v[12:13], v[12:13], v[84:85] op_sel:[0,0] op_sel_hi:[1,1]
    v_pk_add_f32 v[14:15], v[14:15], v[86:87] op_sel:[0,0] op_sel_hi:[1,1]
    v_mov_b32 v84, v12
    v_mov_b32 v85, v13
    v_mov_b32 v86, v14
    v_mov_b32 v87, v15
    v_permlane16_swap_b32 v12, v84
    v_permlane16_swap_b32 v13, v85
    v_permlane16_swap_b32 v14, v86
    v_permlane16_swap_b32 v15, v87
    v_pk_add_f32 v[12:13], v[12:13], v[84:85] op_sel:[0,0] op_sel_hi:[1,1]
    v_pk_add_f32 v[14:15], v[14:15], v[86:87] op_sel:[0,0] op_sel_hi:[1,1]
    v_cvt_pk_bf16_f32 v12, v12, v13
    v_cvt_pk_bf16_f32 v13, v14, v15
    ds_write_b64 v37, v[12:13]
    ds_write_b64 v37, v[12:13] offset:128
KB_KVE:
    s_nop 3
    s_waitcnt lgkmcnt(0)
    s_barrier
    v_lshlrev_b32 v214, 5, v2
    v_lshl_add_u32 v214, v3, 4, v214
    s_lshl_b32 s74, s71, 11
    s_add_u32 s74, s74, 0x1c000
    v_add_u32 v214, s74, v214
    ds_read_b128 v[84:87], v214 offset:0
    ds_read_b128 v[88:91], v214 offset:1024
    s_lshl_b32 s74, s67, 17
    s_lshl_b32 s73, s68, 14
    s_add_u32 s74, s74, s73
    s_lshl_b32 s73, s71, 13
    s_add_u32 s74, s74, s73
    s_lshl_b32 s73, s70, 11
    s_add_u32 s74, s74, s73
    s_add_u32 s74, s74, 0x400000
    v_and_b32 v215, 1, v223
    v_lshl_add_u32 v215, v215, 1, v3
    v_lshrrev_b32 v216, 2, v222
    v_xor_b32 v215, v215, v216
    v_lshlrev_b32 v215, 4, v215
    v_lshl_add_u32 v215, v222, 6, v215
    v_add_u32 v216, s74, v215
    s_mov_b32 s73, 0x358637bd
    s_waitcnt lgkmcnt(0)
    v_mfma_f32_32x32x16_bf16 v[100:115], v[84:87], v[180:183], 0
    v_mfma_f32_32x32x16_bf16 v[116:131], v[88:91], v[184:187], 0
    s_nop 10
    v_cvt_pk_bf16_f32 v132, v108, v108
    v_lshlrev_b32 v132, 16, v132
    v_add_f32 v132, s73, v132
    v_cvt_pk_bf16_f32 v132, v132, v132
    v_lshlrev_b32 v132, 16, v132
    v_rcp_f32 v133, v132
    v_cvt_pk_bf16_f32 v137, v100, v101
    v_lshlrev_b32 v136, 16, v137
    v_and_b32 v137, 0xffff0000, v137
    v_pk_mul_f32 v[100:101], v[136:137], v[132:133] op_sel:[0,1] op_sel_hi:[1,1]
    v_cvt_pk_bf16_f32 v16, v100, v101
    v_cvt_pk_bf16_f32 v137, v102, v103
    v_lshlrev_b32 v136, 16, v137
    v_and_b32 v137, 0xffff0000, v137
    v_pk_mul_f32 v[102:103], v[136:137], v[132:133] op_sel:[0,1] op_sel_hi:[1,1]
    v_cvt_pk_bf16_f32 v17, v102, v103
    v_cvt_pk_bf16_f32 v137, v104, v105
    v_lshlrev_b32 v136, 16, v137
    v_and_b32 v137, 0xffff0000, v137
    v_pk_mul_f32 v[104:105], v[136:137], v[132:133] op_sel:[0,1] op_sel_hi:[1,1]
    v_cvt_pk_bf16_f32 v18, v104, v105
    v_cvt_pk_bf16_f32 v137, v106, v107
    v_lshlrev_b32 v136, 16, v137
    v_and_b32 v137, 0xffff0000, v137
    v_pk_mul_f32 v[106:107], v[136:137], v[132:133] op_sel:[0,1] op_sel_hi:[1,1]
    v_cvt_pk_bf16_f32 v19, v106, v107
    v_cvt_pk_bf16_f32 v132, v124, v124
    v_lshlrev_b32 v132, 16, v132
    v_add_f32 v132, s73, v132
    v_cvt_pk_bf16_f32 v132, v132, v132
    v_lshlrev_b32 v132, 16, v132
    v_rcp_f32 v133, v132
    v_cvt_pk_bf16_f32 v137, v116, v117
    v_lshlrev_b32 v136, 16, v137
    v_and_b32 v137, 0xffff0000, v137
    v_pk_mul_f32 v[116:117], v[136:137], v[132:133] op_sel:[0,1] op_sel_hi:[1,1]
    v_cvt_pk_bf16_f32 v20, v116, v117
    v_cvt_pk_bf16_f32 v137, v118, v119
    v_lshlrev_b32 v136, 16, v137
    v_and_b32 v137, 0xffff0000, v137
    v_pk_mul_f32 v[118:119], v[136:137], v[132:133] op_sel:[0,1] op_sel_hi:[1,1]
    v_cvt_pk_bf16_f32 v21, v118, v119
    v_cvt_pk_bf16_f32 v137, v120, v121
    v_lshlrev_b32 v136, 16, v137
    v_and_b32 v137, 0xffff0000, v137
    v_pk_mul_f32 v[120:121], v[136:137], v[132:133] op_sel:[0,1] op_sel_hi:[1,1]
    v_cvt_pk_bf16_f32 v22, v120, v121
    v_cvt_pk_bf16_f32 v137, v122, v123
    v_lshlrev_b32 v136, 16, v137
    v_and_b32 v137, 0xffff0000, v137
    v_pk_mul_f32 v[122:123], v[136:137], v[132:133] op_sel:[0,1] op_sel_hi:[1,1]
    v_cvt_pk_bf16_f32 v23, v122, v123
    v_permlane16_swap_b32 v16, v20
    v_permlane16_swap_b32 v17, v21
    v_permlane16_swap_b32 v18, v22
    v_permlane16_swap_b32 v19, v23
    buffer_store_dwordx4 v[16:19], v216, s[16:19], 0 offen offset:0 sc1
    buffer_store_dwordx4 v[20:23], v216, s[16:19], 0 offen offset:1024 sc1
    v_and_b32 v215, 0x3fff, v216
    v_add_u32 v215, 0x14000, v215
    ds_write_b128 v215, v[16:19] offset:0
    ds_write_b128 v215, v[20:23] offset:1024
    s_lshl_b32 s72, s69, 4
    s_add_u32 s72, s72, s67
    s_lshl_b32 s72, s72, 10
    s_add_u32 s79, s72, 0x900000
    s_lshl_b32 s73, s68, 7
    s_add_u32 s3, s73, s79
    s_waitcnt vmcnt(0) lgkmcnt(0)
    s_barrier
    s_cmp_lg_u32 s66, 0
    s_cbranch_scc1 KB_FSKIP
    buffer_store_dwordx2 v[220:221], v254, s[16:19], s3 offen
    s_add_u32 s3, s3, 0x10000
    buffer_store_dwordx2 v[220:221], v254, s[16:19], s3 offen sc1
KB_FSKIP:
    v_and_b32 v180, 7, v1
    v_lshlrev_b32 v180, 7, v180
    s_mov_b32 s75, 200000
    s_cmp_lt_u32 s66, 4
    s_cbranch_scc1 KB_NPF
    s_lshl_b32 s74, s67, 17
    s_lshl_b32 s73, s68, 14
    s_add_u32 s74, s74, s73
    s_lshl_b32 s73, s70, 12
    s_add_u32 s74, s74, s73
    s_add_u32 s74, s74, 0x400000
    v_lshl_add_u32 v215, v2, 7, s74
    buffer_load_dword v84, v215, s[16:19], 0 offen
    s_branch KB_NP2
KB_NPF:
    s_nop 1
    s_cmp_lg_u32 s66, 1
    s_cbranch_scc1 KB_NP2
    buffer_load_dwordx2 v[200:201], v180, s[16:19], s79 offen sc1
KB_NP2:
    s_nop 1
    s_lshl_b32 s74, s67, 17
    s_add_u32 s74, s74, s77
    v_lshl_add_u32 v224, v1, 4, s74
    v_bfe_u32 v215, v2, 2, 2
    v_xor_b32 v215, v215, v3
    v_lshlrev_b32 v215, 4, v215
    v_lshl_add_u32 v215, v2, 6, v215
    s_lshl_b32 s73, s70, 11
    v_add_u32 v233, s73, v215
    v_xor_b32 v234, 32, v233
    v_add_u32 v235, 0x14000, v233
    v_add_u32 v236, 0x14000, v234
    v_add_u32 v237, 0x24000, v233
    v_add_u32 v238, 0x24000, v234
    s_lshl_b32 s72, s67, 19
    s_lshl_b32 s73, s70, 17
    s_add_u32 s72, s72, s73
    s_lshl_b32 s73, s68, 8
    s_add_u32 s72, s72, s73
    s_lshl_b32 s73, s71, 7
    s_add_u32 s72, s72, s73
    s_add_u32 s72, s72, 2048
    v_lshlrev_b32 v214, 14, v3
    v_lshl_add_u32 v214, v2, 2, v214
    v_add_u32 v228, s72, v214
    v_lshlrev_b32 v214, 3, v1
    s_cmp_lg_u32 s66, 1
    s_cbranch_scc1 KB_PH1
    s_sleep 3
    buffer_load_dwordx2 v[202:203], v180, s[16:19], s79 offen sc1
KB_PH1:
    s_cmp_lg_u32 s66, 1
    s_cbranch_scc1 KB_PH2
    s_sleep 3
    buffer_load_dwordx2 v[204:205], v180, s[16:19], s79 offen sc1
KB_PH2:
    s_cmp_lg_u32 s66, 1
    s_cbranch_scc1 KB_FOK
KB_FP:
    s_waitcnt vmcnt(2)
    v_xor_b32 v182, v200, v220
    v_xor_b32 v183, v201, v221
    v_or_b32 v182, v182, v183
    v_cmp_ne_u32 vcc, 0, v182
    s_nop 2
    s_cbranch_vccz KB_FOK
    buffer_load_dwordx2 v[200:201], v180, s[16:19], s79 offen sc1
    s_waitcnt vmcnt(2)
    v_xor_b32 v182, v202, v220
    v_xor_b32 v183, v203, v221
    v_or_b32 v182, v182, v183
    v_cmp_ne_u32 vcc, 0, v182
    s_nop 2
    s_cbranch_vccz KB_FOK
    buffer_load_dwordx2 v[202:203], v180, s[16:19], s79 offen sc1
    s_waitcnt vmcnt(2)
    v_xor_b32 v182, v204, v220
    v_xor_b32 v183, v205, v221
    v_or_b32 v182, v182, v183
    v_cmp_ne_u32 vcc, 0, v182
    s_nop 2
    s_cbranch_vccz KB_FOK
    buffer_load_dwordx2 v[204:205], v180, s[16:19], s79 offen sc1
    s_cmp_lg_u32 s75, 199992
    s_cbranch_scc1 KB_FNS
    s_add_u32 s79, s79, 0x10000
KB_FNS:
    s_sub_u32 s75, s75, 1
    s_cmp_lg_u32 s75, 0
    s_cbranch_scc1 KB_FP
KB_FOK:
    s_nop 3
    s_waitcnt vmcnt(8) lgkmcnt(0)
    s_barrier
    s_add_u32 m0, s77, 0x18000
    s_mul_i32 s78, s43, 0x4000
    s_add_u32 s78, s78, 0x400000
    buffer_load_dwordx4 v224, s[16:19], s78 offen sc1 lds
    s_add_u32 m0, s77, 0x18400
    s_mul_i32 s78, s43, 0x4000
    s_add_u32 s78, s78, 0x400400
    buffer_load_dwordx4 v224, s[16:19], s78 offen sc1 lds
    s_add_u32 m0, s77, 0x1c000
    s_mul_i32 s78, s44, 0x4000
    s_add_u32 s78, s78, 0x400000
    buffer_load_dwordx4 v224, s[16:19], s78 offen sc1 lds
    s_add_u32 m0, s77, 0x1c400
    s_mul_i32 s78, s44, 0x4000
    s_add_u32 s78, s78, 0x400400
    buffer_load_dwordx4 v224, s[16:19], s78 offen sc1 lds
    s_add_u32 m0, s77, 0x20000
    s_mul_i32 s78, s45, 0x4000
    s_add_u32 s78, s78, 0x400000
    buffer_load_dwordx4 v224, s[16:19], s78 offen sc1 lds
    s_add_u32 m0, s77, 0x20400
    s_mul_i32 s78, s45, 0x4000
    s_add_u32 s78, s78, 0x400400
    buffer_load_dwordx4 v224, s[16:19], s78 offen sc1 lds
    s_add_u32 m0, s77, 0x24000
    s_mul_i32 s78, s46, 0x4000
    s_add_u32 s78, s78, 0x400000
    buffer_load_dwordx4 v224, s[16:19], s78 offen sc1 lds
    s_add_u32 m0, s77, 0x24400
    s_mul_i32 s78, s46, 0x4000
    s_add_u32 s78, s78, 0x400400
    buffer_load_dwordx4 v224, s[16:19], s78 offen sc1 lds
    s_add_u32 m0, s77, 0x0
    s_mul_i32 s78, s47, 0x4000
    s_add_u32 s78, s78, 0x400000
    buffer_load_dwordx4 v224, s[16:19], s78 offen sc1 lds
    s_add_u32 m0, s77, 0x400
    s_mul_i32 s78, s47, 0x4000
    s_add_u32 s78, s78, 0x400400
    buffer_load_dwordx4 v224, s[16:19], s78 offen sc1 lds
    s_barrier
    ds_read_b128 v[4:7], v235 offset:0
    ds_read_b64_tr_b16 v[8:9], v248 offset:8192
    ds_read_b64_tr_b16 v[10:11], v248 offset:8704
    ds_read_b128 v[12:15], v236 offset:0
    ds_read_b64_tr_b16 v[16:17], v248 offset:10240
    ds_read_b64_tr_b16 v[18:19], v248 offset:10752
    ds_read_b128 v[20:23], v235 offset:8192
    ds_read_b64_tr_b16 v[24:25], v248 offset:12288
    ds_read_b64_tr_b16 v[26:27], v248 offset:12800
    ds_read_b128 v[28:31], v236 offset:8192
    ds_read_b64_tr_b16 v[32:33], v248 offset:14336
    ds_read_b64_tr_b16 v[34:35], v248 offset:14848
    s_waitcnt lgkmcnt(9)
    v_mfma_f32_32x32x16_bf16 v[36:51], v[4:7], v[8:11], 0
    s_waitcnt vmcnt(8)
    s_barrier
    ds_read_b128 v[4:7], v235 offset:16384
    ds_read_b64_tr_b16 v[8:9], v248 offset:0
    ds_read_b64_tr_b16 v[10:11], v248 offset:512
    s_waitcnt lgkmcnt(9)
    v_mfma_f32_32x32x16_bf16 v[36:51], v[12:15], v[16:19], v[36:51]
    ds_read_b128 v[12:15], v236 offset:16384
    ds_read_b64_tr_b16 v[16:17], v248 offset:2048
    ds_read_b64_tr_b16 v[18:19], v248 offset:2560
    s_waitcnt lgkmcnt(9)
    v_mfma_f32_32x32x16_bf16 v[36:51], v[20:23], v[24:27], v[36:51]
    ds_read_b128 v[20:23], v235 offset:24576
    ds_read_b64_tr_b16 v[24:25], v248 offset:4096
    ds_read_b64_tr_b16 v[26:27], v248 offset:4608
    s_waitcnt lgkmcnt(9)
    v_mfma_f32_32x32x16_bf16 v[36:51], v[28:31], v[32:35], v[36:51]
    ds_read_b128 v[28:31], v236 offset:24576
    ds_read_b64_tr_b16 v[32:33], v248 offset:6144
    ds_read_b64_tr_b16 v[34:35], v248 offset:6656
    s_waitcnt lgkmcnt(9)
    v_mfma_f32_32x32x16_bf16 v[36:51], v[4:7], v[8:11], v[36:51]
    s_waitcnt vmcnt(6)
    s_barrier
    ds_read_b128 v[4:7], v235 offset:32768
    ds_read_b64_tr_b16 v[8:9], v248 offset:16384
    ds_read_b64_tr_b16 v[10:11], v248 offset:16896
    s_add_u32 m0, s77, 0x14000
    s_mul_i32 s78, s48, 0x4000
    s_add_u32 s78, s78, 0x400000
    buffer_load_dwordx4 v224, s[16:19], s78 offen sc1 lds
    s_waitcnt lgkmcnt(9)
    v_mfma_f32_32x32x16_bf16 v[36:51], v[12:15], v[16:19], v[36:51]
    s_add_u32 m0, s77, 0x14400
    s_mul_i32 s78, s48, 0x4000
    s_add_u32 s78, s78, 0x400400
    buffer_load_dwordx4 v224, s[16:19], s78 offen sc1 lds
    ds_read_b128 v[12:15], v236 offset:32768
    ds_read_b64_tr_b16 v[16:17], v248 offset:18432
    ds_read_b64_tr_b16 v[18:19], v248 offset:18944
    s_waitcnt lgkmcnt(9)
    v_mfma_f32_32x32x16_bf16 v[36:51], v[20:23], v[24:27], v[36:51]
    ds_read_b128 v[20:23], v235 offset:40960
    ds_read_b64_tr_b16 v[24:25], v248 offset:20480
    ds_read_b64_tr_b16 v[26:27], v248 offset:20992
    s_waitcnt lgkmcnt(9)
    v_mfma_f32_32x32x16_bf16 v[36:51], v[28:31], v[32:35], v[36:51]
    ds_read_b128 v[28:31], v236 offset:40960
    ds_read_b64_tr_b16 v[32:33], v248 offset:22528
    ds_read_b64_tr_b16 v[34:35], v248 offset:23040
    s_waitcnt lgkmcnt(9)
    v_mfma_f32_32x32x16_bf16 v[36:51], v[4:7], v[8:11], v[36:51]
    s_waitcnt vmcnt(6)
    s_barrier
    ds_read_b128 v[4:7], v235 offset:49152
    ds_read_b64_tr_b16 v[8:9], v248 offset:24576
    ds_read_b64_tr_b16 v[10:11], v248 offset:25088
    s_add_u32 m0, s77, 0x18000
    s_mul_i32 s78, s49, 0x4000
    s_add_u32 s78, s78, 0x400000
    buffer_load_dwordx4 v224, s[16:19], s78 offen sc1 lds
    s_waitcnt lgkmcnt(9)
    v_mfma_f32_32x32x16_bf16 v[36:51], v[12:15], v[16:19], v[36:51]
    s_add_u32 m0, s77, 0x18400
    s_mul_i32 s78, s49, 0x4000
    s_add_u32 s78, s78, 0x400400
    buffer_load_dwordx4 v224, s[16:19], s78 offen sc1 lds
    ds_read_b128 v[12:15], v236 offset:49152
    ds_read_b64_tr_b16 v[16:17], v248 offset:26624
    ds_read_b64_tr_b16 v[18:19], v248 offset:27136
    s_waitcnt lgkmcnt(9)
    v_mfma_f32_32x32x16_bf16 v[36:51], v[20:23], v[24:27], v[36:51]
    ds_read_b128 v[20:23], v235 offset:57344
    ds_read_b64_tr_b16 v[24:25], v248 offset:28672
    ds_read_b64_tr_b16 v[26:27], v248 offset:29184
    s_waitcnt lgkmcnt(9)
    v_mfma_f32_32x32x16_bf16 v[36:51], v[28:31], v[32:35], v[36:51]
    ds_read_b128 v[28:31], v236 offset:57344
    ds_read_b64_tr_b16 v[32:33], v248 offset:30720
    ds_read_b64_tr_b16 v[34:35], v248 offset:31232
    s_waitcnt lgkmcnt(9)
    v_mfma_f32_32x32x16_bf16 v[36:51], v[4:7], v[8:11], v[36:51]
    s_waitcnt vmcnt(6)
    s_barrier
    ds_read_b128 v[4:7], v237 offset:0
    ds_read_b64_tr_b16 v[8:9], v248 offset:32768
    ds_read_b64_tr_b16 v[10:11], v248 offset:33280
    s_waitcnt lgkmcnt(9)
    v_mfma_f32_32x32x16_bf16 v[36:51], v[12:15], v[16:19], v[36:51]
    ds_read_b128 v[12:15], v238 offset:0
    ds_read_b64_tr_b16 v[16:17], v248 offset:34816
    ds_read_b64_tr_b16 v[18:19], v248 offset:35328
    s_waitcnt lgkmcnt(9)
    v_mfma_f32_32x32x16_bf16 v[36:51], v[20:23], v[24:27], v[36:51]
    ds_read_b128 v[20:23], v237 offset:8192
    ds_read_b64_tr_b16 v[24:25], v248 offset:36864
    ds_read_b64_tr_b16 v[26:27], v248 offset:37376
    s_waitcnt lgkmcnt(9)
    v_mfma_f32_32x32x16_bf16 v[36:51], v[28:31], v[32:35], v[36:51]
    ds_read_b128 v[28:31], v238 offset:8192
    ds_read_b64_tr_b16 v[32:33], v248 offset:38912
    ds_read_b64_tr_b16 v[34:35], v248 offset:39424
    s_waitcnt lgkmcnt(9)
    v_mfma_f32_32x32x16_bf16 v[36:51], v[4:7], v[8:11], v[36:51]
    s_waitcnt vmcnt(4)
    s_barrier
    ds_read_b128 v[4:7], v233 offset:0
    ds_read_b64_tr_b16 v[8:9], v248 offset:40960
    ds_read_b64_tr_b16 v[10:11], v248 offset:41472
    s_waitcnt lgkmcnt(9)
    v_mfma_f32_32x32x16_bf16 v[36:51], v[12:15], v[16:19], v[36:51]
    ds_read_b128 v[12:15], v234 offset:0
    ds_read_b64_tr_b16 v[16:17], v248 offset:43008
    ds_read_b64_tr_b16 v[18:19], v248 offset:43520
    s_waitcnt lgkmcnt(9)
    v_mfma_f32_32x32x16_bf16 v[36:51], v[20:23], v[24:27], v[36:51]
    ds_read_b128 v[20:23], v233 offset:8192
    ds_read_b64_tr_b16 v[24:25], v248 offset:45056
    ds_read_b64_tr_b16 v[26:27], v248 offset:45568
    s_waitcnt lgkmcnt(9)
    v_mfma_f32_32x32x16_bf16 v[36:51], v[28:31], v[32:35], v[36:51]
    ds_read_b128 v[28:31], v234 offset:8192
    ds_read_b64_tr_b16 v[32:33], v248 offset:47104
    ds_read_b64_tr_b16 v[34:35], v248 offset:47616
    s_waitcnt lgkmcnt(9)
    v_mfma_f32_32x32x16_bf16 v[36:51], v[4:7], v[8:11], v[36:51]
    s_waitcnt vmcnt(2)
    s_barrier
    ds_read_b128 v[4:7], v235 offset:0
    ds_read_b64_tr_b16 v[8:9], v248 offset:49152
    ds_read_b64_tr_b16 v[10:11], v248 offset:49664
    s_waitcnt lgkmcnt(9)
    v_mfma_f32_32x32x16_bf16 v[36:51], v[12:15], v[16:19], v[36:51]
    ds_read_b128 v[12:15], v236 offset:0
    ds_read_b64_tr_b16 v[16:17], v248 offset:51200
    ds_read_b64_tr_b16 v[18:19], v248 offset:51712
    s_waitcnt lgkmcnt(9)
    v_mfma_f32_32x32x16_bf16 v[36:51], v[20:23], v[24:27], v[36:51]
    ds_read_b128 v[20:23], v235 offset:8192
    ds_read_b64_tr_b16 v[24:25], v248 offset:53248
    ds_read_b64_tr_b16 v[26:27], v248 offset:53760
    s_waitcnt lgkmcnt(9)
    v_mfma_f32_32x32x16_bf16 v[36:51], v[28:31], v[32:35], v[36:51]
    ds_read_b128 v[28:31], v236 offset:8192
    ds_read_b64_tr_b16 v[32:33], v248 offset:55296
    ds_read_b64_tr_b16 v[34:35], v248 offset:55808
    s_waitcnt lgkmcnt(9)
    v_mfma_f32_32x32x16_bf16 v[36:51], v[4:7], v[8:11], v[36:51]
    s_waitcnt vmcnt(0)
    s_barrier
    ds_read_b128 v[4:7], v235 offset:16384
    ds_read_b64_tr_b16 v[8:9], v248 offset:57344
    ds_read_b64_tr_b16 v[10:11], v248 offset:57856
    s_waitcnt lgkmcnt(9)
    v_mfma_f32_32x32x16_bf16 v[36:51], v[12:15], v[16:19], v[36:51]
    ds_read_b128 v[12:15], v236 offset:16384
    ds_read_b64_tr_b16 v[16:17], v248 offset:59392
    ds_read_b64_tr_b16 v[18:19], v248 offset:59904
    s_waitcnt lgkmcnt(9)
    v_mfma_f32_32x32x16_bf16 v[36:51], v[20:23], v[24:27], v[36:51]
    ds_read_b128 v[20:23], v235 offset:24576
    ds_read_b64_tr_b16 v[24:25], v248 offset:61440
    ds_read_b64_tr_b16 v[26:27], v248 offset:61952
    s_waitcnt lgkmcnt(9)
    v_mfma_f32_32x32x16_bf16 v[36:51], v[28:31], v[32:35], v[36:51]
    ds_read_b128 v[28:31], v236 offset:24576
    ds_read_b64_tr_b16 v[32:33], v248 offset:63488
    ds_read_b64_tr_b16 v[34:35], v248 offset:64000
    s_waitcnt lgkmcnt(9)
    v_mfma_f32_32x32x16_bf16 v[36:51], v[4:7], v[8:11], v[36:51]
    s_waitcnt lgkmcnt(6)
    v_mfma_f32_32x32x16_bf16 v[36:51], v[12:15], v[16:19], v[36:51]
    s_waitcnt lgkmcnt(3)
    v_mfma_f32_32x32x16_bf16 v[36:51], v[20:23], v[24:27], v[36:51]
    s_waitcnt lgkmcnt(0)
    v_mfma_f32_32x32x16_bf16 v[36:51], v[28:31], v[32:35], v[36:51]
    s_nop 11
    v_cvt_pk_bf16_f32 v149, v36, v37
    v_lshlrev_b32 v148, 16, v149
    v_and_b32 v149, 0xffff0000, v149
    v_cvt_pk_bf16_f32 v151, v38, v39
    v_lshlrev_b32 v150, 16, v151
    v_and_b32 v151, 0xffff0000, v151
    v_cvt_pk_bf16_f32 v153, v40, v41
    v_lshlrev_b32 v152, 16, v153
    v_and_b32 v153, 0xffff0000, v153
    v_cvt_pk_bf16_f32 v155, v42, v43
    v_lshlrev_b32 v154, 16, v155
    v_and_b32 v155, 0xffff0000, v155
    v_cvt_pk_bf16_f32 v157, v44, v45
    v_lshlrev_b32 v156, 16, v157
    v_and_b32 v157, 0xffff0000, v157
    v_cvt_pk_bf16_f32 v159, v46, v47
    v_lshlrev_b32 v158, 16, v159
    v_and_b32 v159, 0xffff0000, v159
    v_cvt_pk_bf16_f32 v161, v48, v49
    v_lshlrev_b32 v160, 16, v161
    v_and_b32 v161, 0xffff0000, v161
    v_cvt_pk_bf16_f32 v163, v50, v51
    v_lshlrev_b32 v162, 16, v163
    v_and_b32 v163, 0xffff0000, v163
    s_mov_b32 s78, 0x0
    buffer_store_dword v148, v228, s[24:27], s78 offen sc1
    s_mov_b32 s78, 0x1000
    buffer_store_dword v149, v228, s[24:27], s78 offen sc1
    s_mov_b32 s78, 0x2000
    buffer_store_dword v150, v228, s[24:27], s78 offen sc1
    s_mov_b32 s78, 0x3000
    buffer_store_dword v151, v228, s[24:27], s78 offen sc1
    s_mov_b32 s78, 0x8000
    buffer_store_dword v152, v228, s[24:27], s78 offen sc1
    s_mov_b32 s78, 0x9000
    buffer_store_dword v153, v228, s[24:27], s78 offen sc1
    s_mov_b32 s78, 0xa000
    buffer_store_dword v154, v228, s[24:27], s78 offen sc1
    s_mov_b32 s78, 0xb000
    buffer_store_dword v155, v228, s[24:27], s78 offen sc1
    s_mov_b32 s78, 0x10000
    buffer_store_dword v156, v228, s[24:27], s78 offen sc1
    s_mov_b32 s78, 0x11000
    buffer_store_dword v157, v228, s[24:27], s78 offen sc1
    s_mov_b32 s78, 0x12000
    buffer_store_dword v158, v228, s[24:27], s78 offen sc1
    s_mov_b32 s78, 0x13000
    buffer_store_dword v159, v228, s[24:27], s78 offen sc1
    s_mov_b32 s78, 0x18000
    buffer_store_dword v160, v228, s[24:27], s78 offen sc1
    s_mov_b32 s78, 0x19000
    buffer_store_dword v161, v228, s[24:27], s78 offen sc1
    s_mov_b32 s78, 0x1a000
    buffer_store_dword v162, v228, s[24:27], s78 offen sc1
    s_mov_b32 s78, 0x1b000
    buffer_store_dword v163, v228, s[24:27], s78 offen sc1
K_END:
    s_endpgm
.section .rodata,"a"
.p2align 6
.amdhsa_kernel concat_heads__ssm_conv_s5__linear_attn_block__prompt_kernel
  .amdhsa_next_free_vgpr 256
  .amdhsa_next_free_sgpr 102
  .amdhsa_accum_offset 256
  .amdhsa_group_segment_fixed_size 0
  .amdhsa_kernarg_size 120
  .amdhsa_user_sgpr_count 2
  .amdhsa_user_sgpr_kernarg_segment_ptr 1
  .amdhsa_system_sgpr_workgroup_id_x 1
.end_amdhsa_kernel
```
